```python
import torch

def _softmax(x, axis=-1):
    return torch.softmax(x, dim=axis)
def _gelu(x):
    return torch.nn.functional.gelu(x, approximate="tanh")
def _silu(x):
    return torch.nn.functional.silu(x)
def _sigmoid(x):
    return torch.sigmoid(x)
def _layernorm(x, axis=-1, eps=1e-5):
    m = x.mean(dim=axis, keepdim=True)
    v = x.var(dim=axis, keepdim=True, unbiased=False)
    return (x - m) / torch.sqrt(v + eps)
def _scatter_add(tgt, idx, src, axis=0):
    return tgt.clone().index_add_(axis, idx, src)
def _segment_sum(src, seg, n):
    out = torch.zeros((n,) + src.shape[1:], dtype=src.dtype)
    return out.index_add_(0, seg, src)
def _pad(x, pw):
    flat = tuple(v for pair in reversed(pw) for v in pair)
    return torch.nn.functional.pad(x, flat)

kernel_name = 'interleave_layers__ssm_conv_s4d__glu_gated_bilinear__prompt'

def setup_inputs():

    _w = (lambda a: (lambda t: t.to(torch.bfloat16) if t.is_floating_point() else t)(torch.as_tensor(a)))
    def _A_setup():
        Bsz, L, D, N = 1, 2048, 512, 128
        return {
            "u": _w((lambda *s: torch.randn(*s, dtype=torch.bfloat16) * 0.05)(Bsz, L, D)),
            "log_A_real": _w((lambda *s: torch.randn(*s, dtype=torch.bfloat16) * 3.2)(D, N) * 0.5),
            "A_imag": _w((lambda *s: torch.randn(*s, dtype=torch.bfloat16) * 0.05)(D, N) * 3.14),
            "C_real": _w((lambda *s: torch.randn(*s, dtype=torch.bfloat16) * 0.05)(D, N) / N ** 0.5),
            "C_imag": _w((lambda *s: torch.randn(*s, dtype=torch.bfloat16) * 0.05)(D, N) / N ** 0.5),
            "log_dt": _w((lambda *s: torch.randn(*s, dtype=torch.bfloat16) * 0.05)(D) * 0.5 - 4.0),
            "D_skip": _w((lambda *s: torch.randn(*s, dtype=torch.bfloat16) * 0.05)(D)),
        }
    _A_in = _A_setup()

    def _B_setup():
        B, S, D, F = 1, 2048, 512, 1376
        return {
            "x": _w((lambda *s: torch.randn(*s, dtype=torch.bfloat16) * 0.05)(B, S, D)),
            "w_gate": _w((lambda *s: torch.randn(*s, dtype=torch.bfloat16) * 0.4)(D, F) * (D ** -0.5)),
            "w_up": _w((lambda *s: torch.randn(*s, dtype=torch.bfloat16) * 0.4)(D, F) * (D ** -0.5)),
            "w_down": _w((lambda *s: torch.randn(*s, dtype=torch.bfloat16) * 0.4)(F, D) * (F ** -0.5)),
        }
    _B_in = _B_setup()

    return {
        "A_u": _A_in["u"],
        "A_log_A_real": _A_in["log_A_real"],
        "A_A_imag": _A_in["A_imag"],
        "A_C_real": _A_in["C_real"],
        "A_C_imag": _A_in["C_imag"],
        "A_log_dt": _A_in["log_dt"],
        "A_D_skip": _A_in["D_skip"],
        "B_x": _B_in["x"],
        "B_w_gate": _B_in["w_gate"],
        "B_w_up": _B_in["w_up"],
        "B_w_down": _B_in["w_down"],
    }

def reference(A_u, A_log_A_real, A_A_imag, A_C_real, A_C_imag, A_log_dt, A_D_skip, B_x, B_w_gate, B_w_up, B_w_down):
    def _A_ref(u, log_A_real, A_imag, C_real, C_imag, log_dt, D_skip):
        L = u.shape[1]
        dt = torch.exp(log_dt)
        A = -torch.exp(log_A_real) + 1j * A_imag
        C = (C_real + 1j * C_imag) * dt[:, None]
        pos = (lambda x, dt: x.to(dt))(torch.arange(L), log_dt.dtype)
        P = torch.exp((A * dt[:, None])[:, :, None] * pos[None, None, :])
        K = 2.0 * torch.einsum("dn,dnl->dl", C, P).real
        L2 = 2 * L
        u_t = (lambda x, *d: x.permute(*d))(u, 0, 2, 1)
        Kf = (lambda x, *a, **k: torch.fft.rfft(x.float(), *a, **k))(K, L2)
        Uf = (lambda x, *a, **k: torch.fft.rfft(x.float(), *a, **k))(u_t, L2)
        y = (lambda x, *a, **k: torch.fft.irfft(x, *a, **k).to(torch.bfloat16))(Uf * Kf[None, :, :], L2)[:, :, :L]
        y = (lambda x, *d: x.permute(*d))(y, 0, 2, 1)
        return y + u * D_skip[None, None, :]

    def _B_ref(x, w_gate, w_up, w_down):
        g = torch.einsum("bsd,df->bsf", x, w_gate)
        u = torch.einsum("bsd,df->bsf", x, w_up)
        h = g * u
        return torch.einsum("bsf,fd->bsd", h, w_down)

    x = A_u
    x = x + _A_ref(_layernorm(x, axis=-1), A_log_A_real, A_A_imag, A_C_real, A_C_imag, A_log_dt, A_D_skip)
    x = x + _B_ref(_layernorm(x, axis=-1), B_w_gate, B_w_up, B_w_down)
    x = x + _A_ref(_layernorm(x, axis=-1), A_log_A_real, A_A_imag, A_C_real, A_C_imag, A_log_dt, A_D_skip)
    x = x + _B_ref(_layernorm(x, axis=-1), B_w_gate, B_w_up, B_w_down)
    return x
```

```asm
; @launch kernel=prep_kernel grid=(768,1,1) block=(256,1,1) lds=41472
; @launch kernel=main_kernel grid=(512,1,1) block=(256,1,1) lds=81920
.amdgcn_target "amdgcn-amd-amdhsa--gfx950"
.text
.globl prep_kernel
.p2align 8
.type prep_kernel,@function
prep_kernel:
    s_getpc_b64 s[52:53]
Lp0:
    s_cmp_ge_u32 s2, 768
    s_cbranch_scc1 Lp_end
    v_min_u32 v2, 63, v0
    v_lshlrev_b32 v2, 7, v2
    global_load_dword v100, v2, s[52:53]
    s_load_dwordx2 s[4:5], s[0:1], 104
    s_load_dwordx8 s[8:15], s[0:1], 0
    v_lshrrev_b32 v2, 6, v0
    v_and_b32 v1, 63, v0
    v_readfirstlane_b32 s3, v2
    s_and_b32 s6, s2, 7
    s_lshr_b32 s7, s2, 3
    s_mov_b32 s44, 0xffff0000
    s_cmp_ge_u32 s2, 512
    s_cbranch_scc0 Lp_k
    s_load_dwordx4 s[36:39], s[0:1], 64
    s_load_dwordx2 s[46:47], s[0:1], 80
    s_and_b32 s7, s7, 31
    s_setprio 1
    s_lshl_b32 s23, s6, 5
    s_add_u32 s23, s23, s7
    s_lshl2_add_u32 s21, s23, s3
    s_lshl_b32 s20, s21, 11
    v_lshl_add_u32 v8, v1, 4, s20
    s_mul_i32 s22, s6, 22
    s_add_u32 s22, s22, s7
    v_lshrrev_b32 v3, 1, v1
    v_mul_u32_u24 v3, 2752, v3
    v_and_b32 v4, 1, v1
    v_lshl_add_u32 v3, v4, 4, v3
    s_cmp_ge_u32 s22, 57
    s_cselect_b32 s34, 1, 0
    s_cselect_b32 s35, 57, 0
    s_sub_u32 s35, s22, s35
    s_lshr_b32 s30, s22, 1
    s_and_b32 s31, s22, 1
    s_cmp_ge_u32 s22, 114
    s_cselect_b32 s34, s31, s34
    s_cselect_b32 s35, s30, s35
    s_lshl_b32 s30, s35, 5
    s_mul_i32 s31, s3, 352256
    s_add_u32 s30, s30, s31
    s_lshl_b32 s33, s3, 13
    s_add_u32 m0, s33, 8704
    s_add_u32 s40, s30, 87040
    s_add_u32 s41, s30, 174080
    s_add_u32 s42, s30, 261120
    s_cmp_lt_u32 s22, 172
    s_cselect_b32 s58, 1409024, 0
    s_mov_b32 s59, 0x20000
    s_sleep 0
    s_cmp_lg_u32 s34, 0
    s_waitcnt lgkmcnt(0)
    global_load_dwordx4 v[64:67], v8, s[8:9] nt
    global_load_dwordx4 v[68:71], v8, s[8:9] offset:1024 nt
    s_cselect_b64 s[56:57], s[38:39], s[36:37]
    s_and_b32 s57, s57, 0xffff
    s_cmp_ge_u32 s7, 22
    s_cbranch_scc1 Lp_wd
    s_sleep 0
    buffer_load_dwordx4 v3, s[56:59], s30 offen nt lds
    buffer_load_dwordx4 v3, s[56:59], s40 offen offset:1024 nt lds
    buffer_load_dwordx4 v3, s[56:59], s41 offen offset:2048 nt lds
    buffer_load_dwordx4 v3, s[56:59], s42 offen offset:3072 nt lds
    s_branch Lp_w2
Lp_k:
    s_setprio 3
    s_load_dwordx4 s[16:19], s[0:1], 32
    s_load_dwordx2 s[48:49], s[0:1], 48
    s_lshl_b32 s23, s6, 6
    s_add_u32 s23, s23, s7
    s_lshl_b32 s21, s23, 8
    v_and_b32 v6, 127, v0
    v_lshl_add_u32 v4, v6, 1, s21
    s_lshl_b32 s22, s23, 1
    v_mov_b32 v5, s22
    s_and_b32 s50, s22, -4
    s_waitcnt lgkmcnt(0)
    global_load_ushort v20, v4, s[10:11] nt
    global_load_ushort v24, v5, s[18:19] nt
    global_load_ushort v21, v4, s[12:13] nt
    global_load_ushort v22, v4, s[14:15] nt
    global_load_ushort v23, v4, s[16:17] nt
    s_load_dword s50, s[48:49], s50
    s_mov_b32 s40, 0x3fb8aa3b
    s_mov_b32 s41, 0x32a57060
    s_mov_b32 s42, 0x3f317218
    s_mov_b32 s24, s4
    s_and_b32 s25, s5, 0xffff
    s_mov_b32 s26, 28835840
    s_mov_b32 s27, 0x20000
    v_lshlrev_b32 v101, 22, v0
    buffer_load_dword v102, v101, s[24:27], 0 offen
    v_and_b32 v12, 15, v1
    v_lshrrev_b32 v17, 4, v1
    v_mul_u32_u24 v13, 544, v12
    v_lshl_add_u32 v13, v17, 4, v13
    s_mul_i32 s39, s3, 8704
    s_add_u32 s39, s39, 8704
    s_cmp_lt_u32 s3, 2
    s_cselect_b32 s32, s39, 0
    s_cselect_b32 s39, 0, s39
    v_add_u32 v88, s32, v13
    v_add_u32 v89, s39, v13
    v_lshrrev_b32 v14, 5, v1
    v_lshlrev_b32 v15, 3, v17
    v_mul_u32_u24 v80, 240, v14
    v_lshl_add_u32 v80, v12, 4, v80
    v_add_u32 v80, v80, v15
    v_lshl_add_u32 v82, v12, 5, v15
    v_sub_u32 v14, 3, v14
    v_lshlrev_b32 v81, v14, v12
    v_lshl_add_u32 v81, v17, 7, v81
    s_cselect_b64 vcc, 0, -1
    v_cndmask_b32 v80, v80, v82, vcc
    s_cselect_b32 s54, -1, 0x01ff01ff
    s_cmp_eq_u32 s3, 1
    s_cselect_b64 vcc, -1, 0
    v_cndmask_b32 v80, v80, v81, vcc
    s_cselect_b32 s55, 0, s54
    s_cselect_b32 s57, -1, 0
    s_mov_b32 s56, 0
    s_mul_i32 s35, s23, 1312
    s_lshl_b32 s37, s3, 9
    s_add_u32 s35, s35, s37
    s_and_b32 s33, s3, 1
    s_lshl_b32 m0, s33, 8
    s_lshr_b32 s31, s7, 4
    s_xor_b32 s31, s31, s3
    s_waitcnt lgkmcnt(0)
    s_lshl_b32 s51, s50, 16
    s_and_b32 s50, s50, s44
    s_bitcmp0_b32 s23, 0
    s_cselect_b32 s50, s51, s50
    s_cmp_eq_u32 s3, 0
    s_cselect_b32 s50, s50, 0
    s_waitcnt vmcnt(4)
    v_lshlrev_b32 v20, 16, v20
    v_lshlrev_b32 v24, 16, v24
    v_mul_f32 v26, s40, v20
    v_mul_f32 v28, s40, v24
    v_fma_f32 v27, v20, s40, -v26
    v_fma_f32 v29, v24, s40, -v28
    v_fmac_f32 v27, s41, v20
    v_fmac_f32 v29, s41, v24
    v_exp_f32 v26, v26
    v_exp_f32 v28, v28
    v_mul_f32 v27, s42, v27
    v_mul_f32 v29, s42, v29
    v_fmac_f32 v26, v26, v27
    v_fmac_f32 v28, v28, v29
    v_cvt_pk_bf16_f32 v25, v26, v28
    v_and_b32 v28, s44, v25
    v_lshlrev_b32 v25, 16, v25
    s_waitcnt vmcnt(3)
    s_setprio 0
    v_lshlrev_b32 v21, 16, v21
    v_mul_f32 v30, v25, v28
    v_mul_f32 v31, v21, v28
    v_mul_f32 v30, 0xbfb8aa3b, v30
    v_mul_f32 v31, 0.15915494, v31
    s_bitcmp1_b32 s31, 1
    s_cbranch_scc1 Lp_hb
    v_mul_f32 v34, 0x41000000, v30
    v_mul_f32 v33, 0x41000000, v31
    v_exp_f32 v34, v34
    v_fract_f32 v33, v33
    v_cos_f32 v32, v33
    v_sin_f32 v33, v33
    v_mul_f32 v38, 0x43000000, v30
    v_mul_f32 v37, 0x43000000, v31
    v_exp_f32 v38, v38
    v_fract_f32 v37, v37
    v_cos_f32 v36, v37
    v_sin_f32 v37, v37
    v_mul_f32 v32, v32, v34
    v_mul_f32 v33, v33, v34
    v_mul_f32 v42, 0x44800000, v30
    v_mul_f32 v41, 0x44800000, v31
    v_exp_f32 v42, v42
    v_fract_f32 v41, v41
    v_cos_f32 v40, v41
    v_sin_f32 v41, v41
    v_mul_f32 v36, v36, v38
    v_mul_f32 v37, v37, v38
    s_waitcnt vmcnt(1)
    v_add_f32 v28, v28, v28
    v_lshlrev_b32 v22, 16, v22
    v_lshlrev_b32 v23, 16, v23
    v_mul_f32 v44, v22, v28
    v_mul_f32 v45, v23, v28
    v_mul_f32 v40, v40, v42
    v_mul_f32 v41, v41, v42
    v_pk_mul_f32 v[50:51], v[44:45], v[32:33] op_sel_hi:[1,0]
    v_pk_mul_f32 v[52:53], v[32:33], v[32:33] op_sel_hi:[1,0]
    v_pk_fma_f32 v[46:47], v[44:45], v[32:33], v[50:51] op_sel:[1,1,0] op_sel_hi:[0,1,1] neg_lo:[1,0,0]
    v_pk_fma_f32 v[48:49], v[32:33], v[32:33], v[52:53] op_sel:[1,1,0] op_sel_hi:[0,1,1] neg_lo:[1,0,0]
    v_pk_mul_f32 v[50:51], v[44:45], v[48:49] op_sel_hi:[1,0]
    v_pk_mul_f32 v[52:53], v[46:47], v[48:49] op_sel_hi:[1,0]
    v_pk_mul_f32 v[54:55], v[40:41], v[36:37] op_sel_hi:[1,0]
    v_cvt_pk_bf16_f32 v60, v44, -v45
    ds_write_addtid_b32 v60 offset:0
    v_cvt_pk_bf16_f32 v61, v46, -v47
    ds_write_addtid_b32 v61 offset:544
    v_cvt_pk_bf16_f32 v62, v40, v41
    ds_write_addtid_b32 v62 offset:26112
    v_pk_fma_f32 v[44:45], v[44:45], v[48:49], v[50:51] op_sel:[1,1,0] op_sel_hi:[0,1,1] neg_lo:[1,0,0]
    v_pk_fma_f32 v[46:47], v[46:47], v[48:49], v[52:53] op_sel:[1,1,0] op_sel_hi:[0,1,1] neg_lo:[1,0,0]
    v_pk_fma_f32 v[40:41], v[40:41], v[36:37], v[54:55] op_sel:[1,1,0] op_sel_hi:[0,1,1] neg_lo:[1,0,0]
    v_pk_mul_f32 v[50:51], v[44:45], v[48:49] op_sel_hi:[1,0]
    v_pk_mul_f32 v[52:53], v[46:47], v[48:49] op_sel_hi:[1,0]
    v_pk_mul_f32 v[54:55], v[40:41], v[36:37] op_sel_hi:[1,0]
    v_cvt_pk_bf16_f32 v63, v44, -v45
    ds_write_addtid_b32 v63 offset:1088
    v_cvt_pk_bf16_f32 v64, v46, -v47
    ds_write_addtid_b32 v64 offset:1632
    v_cvt_pk_bf16_f32 v65, v40, v41
    ds_write_addtid_b32 v65 offset:26656
    v_pk_fma_f32 v[44:45], v[44:45], v[48:49], v[50:51] op_sel:[1,1,0] op_sel_hi:[0,1,1] neg_lo:[1,0,0]
    v_pk_fma_f32 v[46:47], v[46:47], v[48:49], v[52:53] op_sel:[1,1,0] op_sel_hi:[0,1,1] neg_lo:[1,0,0]
    v_pk_fma_f32 v[40:41], v[40:41], v[36:37], v[54:55] op_sel:[1,1,0] op_sel_hi:[0,1,1] neg_lo:[1,0,0]
    v_pk_mul_f32 v[50:51], v[44:45], v[48:49] op_sel_hi:[1,0]
    v_pk_mul_f32 v[52:53], v[46:47], v[48:49] op_sel_hi:[1,0]
    v_pk_mul_f32 v[54:55], v[40:41], v[36:37] op_sel_hi:[1,0]
    v_cvt_pk_bf16_f32 v66, v44, -v45
    ds_write_addtid_b32 v66 offset:2176
    v_cvt_pk_bf16_f32 v67, v46, -v47
    ds_write_addtid_b32 v67 offset:2720
    v_cvt_pk_bf16_f32 v60, v40, v41
    ds_write_addtid_b32 v60 offset:27200
    v_pk_fma_f32 v[44:45], v[44:45], v[48:49], v[50:51] op_sel:[1,1,0] op_sel_hi:[0,1,1] neg_lo:[1,0,0]
    v_pk_fma_f32 v[46:47], v[46:47], v[48:49], v[52:53] op_sel:[1,1,0] op_sel_hi:[0,1,1] neg_lo:[1,0,0]
    v_pk_fma_f32 v[40:41], v[40:41], v[36:37], v[54:55] op_sel:[1,1,0] op_sel_hi:[0,1,1] neg_lo:[1,0,0]
    v_pk_mul_f32 v[50:51], v[44:45], v[48:49] op_sel_hi:[1,0]
    v_pk_mul_f32 v[52:53], v[46:47], v[48:49] op_sel_hi:[1,0]
    v_pk_mul_f32 v[54:55], v[40:41], v[36:37] op_sel_hi:[1,0]
    v_cvt_pk_bf16_f32 v61, v44, -v45
    ds_write_addtid_b32 v61 offset:3264
    v_cvt_pk_bf16_f32 v62, v46, -v47
    ds_write_addtid_b32 v62 offset:3808
    v_cvt_pk_bf16_f32 v63, v40, v41
    ds_write_addtid_b32 v63 offset:27744
    v_pk_fma_f32 v[44:45], v[44:45], v[48:49], v[50:51] op_sel:[1,1,0] op_sel_hi:[0,1,1] neg_lo:[1,0,0]
    v_pk_fma_f32 v[46:47], v[46:47], v[48:49], v[52:53] op_sel:[1,1,0] op_sel_hi:[0,1,1] neg_lo:[1,0,0]
    v_pk_fma_f32 v[40:41], v[40:41], v[36:37], v[54:55] op_sel:[1,1,0] op_sel_hi:[0,1,1] neg_lo:[1,0,0]
    v_pk_mul_f32 v[50:51], v[44:45], v[48:49] op_sel_hi:[1,0]
    v_pk_mul_f32 v[52:53], v[46:47], v[48:49] op_sel_hi:[1,0]
    v_pk_mul_f32 v[54:55], v[40:41], v[36:37] op_sel_hi:[1,0]
    v_cvt_pk_bf16_f32 v64, v44, -v45
    ds_write_addtid_b32 v64 offset:4352
    v_cvt_pk_bf16_f32 v65, v46, -v47
    ds_write_addtid_b32 v65 offset:4896
    v_cvt_pk_bf16_f32 v66, v40, v41
    ds_write_addtid_b32 v66 offset:28288
    v_pk_fma_f32 v[44:45], v[44:45], v[48:49], v[50:51] op_sel:[1,1,0] op_sel_hi:[0,1,1] neg_lo:[1,0,0]
    v_pk_fma_f32 v[46:47], v[46:47], v[48:49], v[52:53] op_sel:[1,1,0] op_sel_hi:[0,1,1] neg_lo:[1,0,0]
    v_pk_fma_f32 v[40:41], v[40:41], v[36:37], v[54:55] op_sel:[1,1,0] op_sel_hi:[0,1,1] neg_lo:[1,0,0]
    v_pk_mul_f32 v[50:51], v[44:45], v[48:49] op_sel_hi:[1,0]
    v_pk_mul_f32 v[52:53], v[46:47], v[48:49] op_sel_hi:[1,0]
    v_pk_mul_f32 v[54:55], v[40:41], v[36:37] op_sel_hi:[1,0]
    v_cvt_pk_bf16_f32 v67, v44, -v45
    ds_write_addtid_b32 v67 offset:5440
    v_cvt_pk_bf16_f32 v60, v46, -v47
    ds_write_addtid_b32 v60 offset:5984
    v_cvt_pk_bf16_f32 v61, v40, v41
    ds_write_addtid_b32 v61 offset:28832
    v_pk_fma_f32 v[44:45], v[44:45], v[48:49], v[50:51] op_sel:[1,1,0] op_sel_hi:[0,1,1] neg_lo:[1,0,0]
    v_pk_fma_f32 v[46:47], v[46:47], v[48:49], v[52:53] op_sel:[1,1,0] op_sel_hi:[0,1,1] neg_lo:[1,0,0]
    v_pk_fma_f32 v[40:41], v[40:41], v[36:37], v[54:55] op_sel:[1,1,0] op_sel_hi:[0,1,1] neg_lo:[1,0,0]
    v_pk_mul_f32 v[50:51], v[44:45], v[48:49] op_sel_hi:[1,0]
    v_pk_mul_f32 v[52:53], v[46:47], v[48:49] op_sel_hi:[1,0]
    v_pk_mul_f32 v[54:55], v[40:41], v[36:37] op_sel_hi:[1,0]
    v_cvt_pk_bf16_f32 v62, v44, -v45
    ds_write_addtid_b32 v62 offset:6528
    v_cvt_pk_bf16_f32 v63, v46, -v47
    ds_write_addtid_b32 v63 offset:7072
    v_cvt_pk_bf16_f32 v64, v40, v41
    ds_write_addtid_b32 v64 offset:29376
    v_pk_fma_f32 v[44:45], v[44:45], v[48:49], v[50:51] op_sel:[1,1,0] op_sel_hi:[0,1,1] neg_lo:[1,0,0]
    v_pk_fma_f32 v[46:47], v[46:47], v[48:49], v[52:53] op_sel:[1,1,0] op_sel_hi:[0,1,1] neg_lo:[1,0,0]
    v_pk_fma_f32 v[40:41], v[40:41], v[36:37], v[54:55] op_sel:[1,1,0] op_sel_hi:[0,1,1] neg_lo:[1,0,0]
    v_pk_mul_f32 v[54:55], v[40:41], v[36:37] op_sel_hi:[1,0]
    v_cvt_pk_bf16_f32 v65, v44, -v45
    ds_write_addtid_b32 v65 offset:7616
    v_cvt_pk_bf16_f32 v66, v46, -v47
    ds_write_addtid_b32 v66 offset:8160
    v_cvt_pk_bf16_f32 v67, v40, v41
    ds_write_addtid_b32 v67 offset:29920
    v_pk_fma_f32 v[40:41], v[40:41], v[36:37], v[54:55] op_sel:[1,1,0] op_sel_hi:[0,1,1] neg_lo:[1,0,0]
    v_cvt_pk_bf16_f32 v60, v40, v41
    ds_write_addtid_b32 v60 offset:30464
    s_branch Lp_x
Lp_hb:
    v_exp_f32 v36, v30
    v_fract_f32 v35, v31
    v_cos_f32 v34, v35
    v_sin_f32 v35, v35
    v_mul_f32 v50, 0x43000000, v30
    v_mul_f32 v49, 0x43000000, v31
    v_exp_f32 v50, v50
    v_fract_f32 v49, v49
    v_cos_f32 v48, v49
    v_sin_f32 v49, v49
    v_mul_f32 v34, v34, v36
    v_mul_f32 v35, v35, v36
    v_mov_b32 v60, 0x3f80
    v_mul_f32 v48, v48, v50
    v_mul_f32 v49, v49, v50
    ds_write_addtid_b32 v60 offset:8704
    v_pk_mul_f32 v[52:53], v[34:35], v[34:35] op_sel_hi:[1,0]
    v_cvt_pk_bf16_f32 v61, v34, v35
    ds_write_addtid_b32 v61 offset:9248
    v_pk_fma_f32 v[36:37], v[34:35], v[34:35], v[52:53] op_sel:[1,1,0] op_sel_hi:[0,1,1] neg_lo:[1,0,0]
    v_cvt_pk_bf16_f32 v62, v48, v49
    ds_write_addtid_b32 v62 offset:13056
    v_pk_mul_f32 v[52:53], v[36:37], v[34:35] op_sel_hi:[1,0]
    v_pk_mul_f32 v[54:55], v[36:37], v[36:37] op_sel_hi:[1,0]
    v_cvt_pk_bf16_f32 v63, v36, v37
    ds_write_addtid_b32 v63 offset:9792
    v_pk_fma_f32 v[38:39], v[36:37], v[34:35], v[52:53] op_sel:[1,1,0] op_sel_hi:[0,1,1] neg_lo:[1,0,0]
    v_pk_fma_f32 v[40:41], v[36:37], v[36:37], v[54:55] op_sel:[1,1,0] op_sel_hi:[0,1,1] neg_lo:[1,0,0]
    v_pk_mul_f32 v[58:59], v[48:49], v[48:49] op_sel_hi:[1,0]
    v_pk_mul_f32 v[52:53], v[40:41], v[34:35] op_sel_hi:[1,0]
    v_pk_mul_f32 v[54:55], v[40:41], v[36:37] op_sel_hi:[1,0]
    v_pk_mul_f32 v[56:57], v[40:41], v[38:39] op_sel_hi:[1,0]
    v_cvt_pk_bf16_f32 v64, v38, v39
    ds_write_addtid_b32 v64 offset:10336
    v_cvt_pk_bf16_f32 v65, v40, v41
    ds_write_addtid_b32 v65 offset:10880
    v_pk_fma_f32 v[32:33], v[48:49], v[48:49], v[58:59] op_sel:[1,1,0] op_sel_hi:[0,1,1] neg_lo:[1,0,0]
    v_pk_fma_f32 v[42:43], v[40:41], v[34:35], v[52:53] op_sel:[1,1,0] op_sel_hi:[0,1,1] neg_lo:[1,0,0]
    v_pk_fma_f32 v[44:45], v[40:41], v[36:37], v[54:55] op_sel:[1,1,0] op_sel_hi:[0,1,1] neg_lo:[1,0,0]
    v_pk_fma_f32 v[46:47], v[40:41], v[38:39], v[56:57] op_sel:[1,1,0] op_sel_hi:[0,1,1] neg_lo:[1,0,0]
    v_cvt_pk_bf16_f32 v66, v32, v33
    ds_write_addtid_b32 v66 offset:17408
    v_cvt_pk_bf16_f32 v67, v42, v43
    ds_write_addtid_b32 v67 offset:11424
    v_cvt_pk_bf16_f32 v60, v44, v45
    ds_write_addtid_b32 v60 offset:11968
    v_cvt_pk_bf16_f32 v61, v46, v47
    ds_write_addtid_b32 v61 offset:12512
    v_pk_mul_f32 v[50:51], v[36:37], v[48:49] op_sel_hi:[1,0]
    v_pk_mul_f32 v[52:53], v[40:41], v[48:49] op_sel_hi:[1,0]
    v_pk_mul_f32 v[54:55], v[44:45], v[48:49] op_sel_hi:[1,0]
    v_pk_mul_f32 v[56:57], v[32:33], v[48:49] op_sel_hi:[1,0]
    v_pk_fma_f32 v[36:37], v[36:37], v[48:49], v[50:51] op_sel:[1,1,0] op_sel_hi:[0,1,1] neg_lo:[1,0,0]
    v_pk_fma_f32 v[40:41], v[40:41], v[48:49], v[52:53] op_sel:[1,1,0] op_sel_hi:[0,1,1] neg_lo:[1,0,0]
    v_pk_fma_f32 v[44:45], v[44:45], v[48:49], v[54:55] op_sel:[1,1,0] op_sel_hi:[0,1,1] neg_lo:[1,0,0]
    v_pk_fma_f32 v[32:33], v[32:33], v[48:49], v[56:57] op_sel:[1,1,0] op_sel_hi:[0,1,1] neg_lo:[1,0,0]
    v_cvt_pk_bf16_f32 v62, v36, v37
    ds_write_addtid_b32 v62 offset:14144
    v_cvt_pk_bf16_f32 v63, v40, v41
    ds_write_addtid_b32 v63 offset:15232
    v_cvt_pk_bf16_f32 v64, v44, v45
    ds_write_addtid_b32 v64 offset:16320
    v_cvt_pk_bf16_f32 v65, v32, v33
    ds_write_addtid_b32 v65 offset:19584
    v_pk_mul_f32 v[50:51], v[34:35], v[48:49] op_sel_hi:[1,0]
    v_pk_mul_f32 v[52:53], v[38:39], v[48:49] op_sel_hi:[1,0]
    v_pk_mul_f32 v[54:55], v[42:43], v[48:49] op_sel_hi:[1,0]
    v_pk_mul_f32 v[56:57], v[46:47], v[48:49] op_sel_hi:[1,0]
    v_pk_fma_f32 v[34:35], v[34:35], v[48:49], v[50:51] op_sel:[1,1,0] op_sel_hi:[0,1,1] neg_lo:[1,0,0]
    v_pk_fma_f32 v[38:39], v[38:39], v[48:49], v[52:53] op_sel:[1,1,0] op_sel_hi:[0,1,1] neg_lo:[1,0,0]
    v_pk_fma_f32 v[42:43], v[42:43], v[48:49], v[54:55] op_sel:[1,1,0] op_sel_hi:[0,1,1] neg_lo:[1,0,0]
    v_pk_fma_f32 v[46:47], v[46:47], v[48:49], v[56:57] op_sel:[1,1,0] op_sel_hi:[0,1,1] neg_lo:[1,0,0]
    v_cvt_pk_bf16_f32 v66, v34, v35
    ds_write_addtid_b32 v66 offset:13600
    v_cvt_pk_bf16_f32 v67, v38, v39
    ds_write_addtid_b32 v67 offset:14688
    v_cvt_pk_bf16_f32 v60, v42, v43
    ds_write_addtid_b32 v60 offset:15776
    v_cvt_pk_bf16_f32 v61, v46, v47
    ds_write_addtid_b32 v61 offset:16864
    v_pk_mul_f32 v[50:51], v[36:37], v[48:49] op_sel_hi:[1,0]
    v_pk_mul_f32 v[52:53], v[40:41], v[48:49] op_sel_hi:[1,0]
    v_pk_mul_f32 v[54:55], v[44:45], v[48:49] op_sel_hi:[1,0]
    v_pk_mul_f32 v[56:57], v[32:33], v[48:49] op_sel_hi:[1,0]
    v_pk_fma_f32 v[36:37], v[36:37], v[48:49], v[50:51] op_sel:[1,1,0] op_sel_hi:[0,1,1] neg_lo:[1,0,0]
    v_pk_fma_f32 v[40:41], v[40:41], v[48:49], v[52:53] op_sel:[1,1,0] op_sel_hi:[0,1,1] neg_lo:[1,0,0]
    v_pk_fma_f32 v[44:45], v[44:45], v[48:49], v[54:55] op_sel:[1,1,0] op_sel_hi:[0,1,1] neg_lo:[1,0,0]
    v_pk_fma_f32 v[32:33], v[32:33], v[48:49], v[56:57] op_sel:[1,1,0] op_sel_hi:[0,1,1] neg_lo:[1,0,0]
    v_cvt_pk_bf16_f32 v62, v36, v37
    ds_write_addtid_b32 v62 offset:17952
    v_cvt_pk_bf16_f32 v63, v40, v41
    ds_write_addtid_b32 v63 offset:18496
    v_cvt_pk_bf16_f32 v64, v44, v45
    ds_write_addtid_b32 v64 offset:19040
    v_cvt_pk_bf16_f32 v65, v32, v33
    ds_write_addtid_b32 v65 offset:21760
    v_pk_mul_f32 v[50:51], v[36:37], v[48:49] op_sel_hi:[1,0]
    v_pk_mul_f32 v[52:53], v[40:41], v[48:49] op_sel_hi:[1,0]
    v_pk_mul_f32 v[54:55], v[44:45], v[48:49] op_sel_hi:[1,0]
    v_pk_mul_f32 v[56:57], v[32:33], v[48:49] op_sel_hi:[1,0]
    v_pk_fma_f32 v[36:37], v[36:37], v[48:49], v[50:51] op_sel:[1,1,0] op_sel_hi:[0,1,1] neg_lo:[1,0,0]
    v_pk_fma_f32 v[40:41], v[40:41], v[48:49], v[52:53] op_sel:[1,1,0] op_sel_hi:[0,1,1] neg_lo:[1,0,0]
    v_pk_fma_f32 v[44:45], v[44:45], v[48:49], v[54:55] op_sel:[1,1,0] op_sel_hi:[0,1,1] neg_lo:[1,0,0]
    v_pk_fma_f32 v[32:33], v[32:33], v[48:49], v[56:57] op_sel:[1,1,0] op_sel_hi:[0,1,1] neg_lo:[1,0,0]
    v_cvt_pk_bf16_f32 v66, v36, v37
    ds_write_addtid_b32 v66 offset:20128
    v_cvt_pk_bf16_f32 v67, v40, v41
    ds_write_addtid_b32 v67 offset:20672
    v_cvt_pk_bf16_f32 v60, v44, v45
    ds_write_addtid_b32 v60 offset:21216
    v_cvt_pk_bf16_f32 v61, v32, v33
    ds_write_addtid_b32 v61 offset:22848
    v_pk_mul_f32 v[50:51], v[40:41], v[48:49] op_sel_hi:[1,0]
    v_pk_mul_f32 v[52:53], v[32:33], v[48:49] op_sel_hi:[1,0]
    v_pk_fma_f32 v[40:41], v[40:41], v[48:49], v[50:51] op_sel:[1,1,0] op_sel_hi:[0,1,1] neg_lo:[1,0,0]
    v_pk_fma_f32 v[32:33], v[32:33], v[48:49], v[52:53] op_sel:[1,1,0] op_sel_hi:[0,1,1] neg_lo:[1,0,0]
    v_cvt_pk_bf16_f32 v62, v40, v41
    ds_write_addtid_b32 v62 offset:22304
    v_cvt_pk_bf16_f32 v63, v32, v33
    ds_write_addtid_b32 v63 offset:23936
    v_pk_mul_f32 v[50:51], v[40:41], v[48:49] op_sel_hi:[1,0]
    v_pk_mul_f32 v[52:53], v[32:33], v[48:49] op_sel_hi:[1,0]
    v_pk_fma_f32 v[40:41], v[40:41], v[48:49], v[50:51] op_sel:[1,1,0] op_sel_hi:[0,1,1] neg_lo:[1,0,0]
    v_pk_fma_f32 v[32:33], v[32:33], v[48:49], v[52:53] op_sel:[1,1,0] op_sel_hi:[0,1,1] neg_lo:[1,0,0]
    v_cvt_pk_bf16_f32 v64, v40, v41
    ds_write_addtid_b32 v64 offset:23392
    v_cvt_pk_bf16_f32 v65, v32, v33
    ds_write_addtid_b32 v65 offset:25024
    v_pk_mul_f32 v[50:51], v[40:41], v[48:49] op_sel_hi:[1,0]
    v_pk_fma_f32 v[40:41], v[40:41], v[48:49], v[50:51] op_sel:[1,1,0] op_sel_hi:[0,1,1] neg_lo:[1,0,0]
    v_cvt_pk_bf16_f32 v66, v40, v41
    ds_write_addtid_b32 v66 offset:24480
    v_pk_mul_f32 v[50:51], v[40:41], v[48:49] op_sel_hi:[1,0]
    v_pk_fma_f32 v[40:41], v[40:41], v[48:49], v[50:51] op_sel:[1,1,0] op_sel_hi:[0,1,1] neg_lo:[1,0,0]
    v_cvt_pk_bf16_f32 v67, v40, v41
    ds_write_addtid_b32 v67 offset:25568
Lp_x:
    v_mov_b32 v28, 0
    v_mov_b32 v29, 0
    v_mov_b32 v30, 0
    v_mov_b32 v31, 0
    v_writelane_b32 v28, s50, 0
    s_cmp_eq_u32 s3, 3
    s_waitcnt lgkmcnt(0)
    s_barrier
    s_cbranch_scc1 Lp_end2
    ds_read_b128 v[32:35], v88 offset:0
    ds_read_b128 v[36:39], v89 offset:0
    ds_read_b128 v[40:43], v88 offset:64
    ds_read_b128 v[44:47], v89 offset:64
    ds_read_b128 v[48:51], v88 offset:128
    ds_read_b128 v[52:55], v89 offset:128
    ds_read_b128 v[56:59], v88 offset:192
    ds_read_b128 v[60:63], v89 offset:192
    ds_read_b128 v[64:67], v88 offset:256
    ds_read_b128 v[68:71], v89 offset:256
    ds_read_b128 v[72:75], v88 offset:320
    ds_read_b128 v[76:79], v89 offset:320
    ds_read_b128 v[8:11], v88 offset:384
    ds_read_b128 v[12:15], v89 offset:384
    s_waitcnt lgkmcnt(12)
    v_mfma_f32_16x16x32_bf16 v[28:31], v[32:35], v[36:39], v[28:31]
    ds_read_b128 v[16:19], v88 offset:448
    ds_read_b128 v[24:27], v89 offset:448
    s_waitcnt lgkmcnt(12)
    v_mfma_f32_16x16x32_bf16 v[28:31], v[40:43], v[44:47], v[28:31]
    s_waitcnt lgkmcnt(10)
    v_mfma_f32_16x16x32_bf16 v[28:31], v[48:51], v[52:55], v[28:31]
    s_waitcnt lgkmcnt(8)
    v_mfma_f32_16x16x32_bf16 v[28:31], v[56:59], v[60:63], v[28:31]
    s_waitcnt lgkmcnt(6)
    v_mfma_f32_16x16x32_bf16 v[28:31], v[64:67], v[68:71], v[28:31]
    s_waitcnt lgkmcnt(4)
    v_mfma_f32_16x16x32_bf16 v[28:31], v[72:75], v[76:79], v[28:31]
    s_waitcnt lgkmcnt(2)
    v_mfma_f32_16x16x32_bf16 v[28:31], v[8:11], v[12:15], v[28:31]
    s_waitcnt lgkmcnt(0)
    v_mfma_f32_16x16x32_bf16 v[28:31], v[16:19], v[24:27], v[28:31]
    s_nop 7
    v_cvt_pk_bf16_f32 v28, v28, v29
    v_cvt_pk_bf16_f32 v29, v30, v31
    s_mov_b64 exec, s[54:55]
    buffer_store_dwordx2 v[28:29], v80, s[24:27], s35 offen
    s_mov_b64 exec, s[56:57]
    s_cbranch_execz Lp_end2
    buffer_store_dword v28, v80, s[24:27], s35 offen
    buffer_store_dword v29, v80, s[24:27], s35 offen offset:64
Lp_end2:
    s_endpgm
Lp_w2:
    s_mul_i32 s36, s35, 3
    s_and_b32 s37, s35, 1
    s_add_u32 s37, s37, s34
    s_add_u32 s37, s37, s36
    s_lshl_b32 s37, s37, 14
    s_lshl_b32 s36, s36, 15
    s_lshl_b32 s34, s34, 5
    s_add_u32 s36, s36, s34
    s_sub_u32 s36, s36, 5570560
    s_cmp_ge_u32 s22, 114
    s_cselect_b32 s32, s36, s37
    s_cselect_b64 vcc, -1, 0
    s_lshl_b32 s33, s3, 12
    s_add_u32 s32, s32, s33
    s_add_u32 s32, s32, 26017792
    v_lshl_add_u32 v7, v1, 3, m0
    v_and_b32 v4, 0x31, v1
    v_and_b32 v6, 6, v1
    v_lshl_add_u32 v4, v6, 1, v4
    v_and_b32 v6, 8, v1
    v_lshl_add_u32 v4, v6, 7, v4
    v_cndmask_b32 v4, v1, v4, vcc
    v_lshlrev_b32 v4, 4, v4
    v_and_b32 v2, 15, v1
    v_lshlrev_b32 v2, 4, v2
    v_add_u32 v2, 8448, v2
    s_lshl_b32 s33, s3, 2
    v_add_u32 v5, s33, v2
    s_mov_b32 s40, 0xbb000000
    v_mov_b32 v72, 0
    v_mov_b32 v73, 0
    s_branch Lp_xa
Lp_wd:
    s_sub_u32 s45, s7, 22
    s_lshl_b32 s30, s45, 3
    s_add_u32 s30, s30, s6
    s_lshl_b32 s30, s30, 2
    s_add_u32 s30, s30, s3
    s_lshl_b32 s45, s45, 2
    s_add_u32 s45, s45, s3
    s_lshl_b32 s45, s45, 11
    s_add_u32 s45, s45, Lpf_start-Lp0
    v_lshl_add_u32 v6, v1, 5, s45
    v_min_u32 v6, Lcode_end-Lp0-24, v6
    s_mov_b32 s58, 1409024
    global_load_dword v8, v6, s[52:53]
    s_lshr_b32 s32, s30, 3
    s_and_b32 s33, s30, 7
    s_lshl_b32 s35, s33, 7
    v_lshlrev_b32 v4, 4, v1
    v_lshrrev_b32 v10, 3, v1
    v_and_b32 v7, 0x70, v4
    v_and_b32 v9, 4, v10
    v_add_u32 v6, v9, v10
    v_lshl_add_u32 v6, v6, 10, v7
    v_lshl_add_u32 v10, v10, 10, v7
    v_lshrrev_b32 v5, 4, v1
    v_bfe_u32 v7, v1, 2, 2
    v_lshlrev_b32 v7, 7, v7
    v_lshl_add_u32 v5, v5, 10, v7
    v_and_b32 v7, 3, v1
    v_lshlrev_b32 v7, 3, v7
    v_add3_u32 v5, v5, v7, m0
    s_mul_i32 s33, s33, 44
    s_add_u32 s33, s33, s32
    s_lshl_b32 s33, s33, 12
    s_add_u32 s33, s33, 24444928
    s_lshl_b32 s32, s32, 2
    s_mov_b32 s31, s30
    s_sleep 10
    s_mov_b32 s56, s46
    s_and_b32 s57, s47, 0xffff
Lp_rl:
    s_mul_i32 s36, s32, 21846
    s_lshr_b32 s36, s36, 16
    s_mul_i32 s37, s36, 3
    s_sub_u32 s37, s32, s37
    s_lshl2_add_u32 s38, s36, s37
    s_lshl_b32 s38, s38, 2
    s_lshl3_add_u32 s36, s36, 912
    s_cmp_eq_u32 s37, 2
    s_cselect_b32 s36, s36, s38
    s_cselect_b64 vcc, -1, 0
    s_lshl_b32 s36, s36, 10
    s_add_u32 s36, s36, s35
    v_cndmask_b32 v9, v6, v10, vcc
    s_add_u32 s32, s32, 1
    buffer_load_dwordx4 v9, s[56:59], s36 offen nt lds
    s_add_u32 m0, m0, 1024
    s_and_b32 s39, s32, 3
    s_cbranch_scc1 Lp_rl
    s_add_u32 s32, s32, 156
    s_add_u32 s31, s31, 320
    s_cmp_lt_u32 s31, 352
    s_cbranch_scc1 Lp_rl
Lp_xa:
    s_mov_b32 s24, s4
    s_and_b32 s25, s5, 0xffff
    s_mov_b32 s26, 28835840
    s_mov_b32 s27, 0x20000
    s_mul_i32 s28, s3, 2112
    v_lshl_add_u32 v93, v1, 4, s28
    v_and_b32 v12, 1, v0
    v_lshrrev_b32 v13, 1, v0
    v_mul_u32_u24 v91, 4224, v12
    v_lshl_add_u32 v91, v13, 2, v91
    v_lshlrev_b32 v12, 4, v12
    v_lshl_add_u32 v92, v13, 13, v12
    s_lshl_b32 s29, s23, 5
    s_add_u32 s29, s29, 4259840
    s_add_u32 s28, s29, 1048576
    s_mov_b32 s43, 0x3f803f80
    v_mov_b32 v76, 0
    v_mov_b32 v77, 0
    v_mov_b32 v78, 0
    v_mov_b32 v79, 0
    s_mul_i32 s16, s23, 4352
    s_add_u32 s16, s16, 720640
    s_lshl_b32 s17, s23, 6
    s_add_u32 s17, s17, 25919488
    v_lshl_add_u32 v20, v0, 4, s17
    v_add_u32 v22, 4, v0
    v_lshrrev_b32 v21, 3, v22
    v_lshlrev_b32 v21, 7, v21
    v_lshl_add_u32 v21, v22, 4, v21
    v_add_u32 v21, s16, v21
    v_cmp_gt_u32 vcc, 4, v0
    s_nop 1
    v_cndmask_b32 v20, v21, v20, vcc
    v_cmp_gt_u32 vcc, 60, v0
    s_nop 1
    v_cndmask_b32 v20, 2.0, v20, vcc
    s_lshl_b32 s21, s21, 3
    v_mov_b32 v26, s21
    s_mov_b32 s18, 25886720
    s_mov_b32 s19, 25894912
    buffer_store_dwordx4 v[76:79], v20, s[24:27], 0 offen
    s_waitcnt vmcnt(5)
    ds_write_b128 v93, v[64:67] offset:0
    ds_write_b128 v93, v[68:71] offset:1056
    v_dot2c_f32_bf16 v76, s43, v64
    v_dot2c_f32_bf16 v78, v64, v64
    v_dot2c_f32_bf16 v77, s43, v68
    v_dot2c_f32_bf16 v79, v68, v68
    v_dot2c_f32_bf16 v76, s43, v65
    v_dot2c_f32_bf16 v78, v65, v65
    v_dot2c_f32_bf16 v77, s43, v69
    v_dot2c_f32_bf16 v79, v69, v69
    v_dot2c_f32_bf16 v76, s43, v66
    v_dot2c_f32_bf16 v78, v66, v66
    v_dot2c_f32_bf16 v77, s43, v70
    v_dot2c_f32_bf16 v79, v70, v70
    v_dot2c_f32_bf16 v76, s43, v67
    v_dot2c_f32_bf16 v78, v67, v67
    v_dot2c_f32_bf16 v77, s43, v71
    v_dot2c_f32_bf16 v79, v71, v71
    s_waitcnt lgkmcnt(0)
    s_barrier
    ds_read_b32 v80, v91 offset:0
    ds_read_b32 v81, v91 offset:1056
    ds_read_b32 v82, v91 offset:2112
    ds_read_b32 v83, v91 offset:3168
    ds_read_b32 v84, v91 offset:512
    ds_read_b32 v85, v91 offset:1568
    ds_read_b32 v86, v91 offset:2624
    ds_read_b32 v87, v91 offset:3680
    v_add_f32_dpp v76, v76, v76 row_shr:1 row_mask:0xf bank_mask:0xf
    v_add_f32_dpp v77, v77, v77 row_shr:1 row_mask:0xf bank_mask:0xf
    v_add_f32_dpp v78, v78, v78 row_shr:1 row_mask:0xf bank_mask:0xf
    v_add_f32_dpp v79, v79, v79 row_shr:1 row_mask:0xf bank_mask:0xf
    v_add_f32_dpp v76, v76, v76 row_shr:2 row_mask:0xf bank_mask:0xf
    v_add_f32_dpp v77, v77, v77 row_shr:2 row_mask:0xf bank_mask:0xf
    v_add_f32_dpp v78, v78, v78 row_shr:2 row_mask:0xf bank_mask:0xf
    v_add_f32_dpp v79, v79, v79 row_shr:2 row_mask:0xf bank_mask:0xf
    v_add_f32_dpp v76, v76, v76 row_shr:4 row_mask:0xf bank_mask:0xf
    v_add_f32_dpp v77, v77, v77 row_shr:4 row_mask:0xf bank_mask:0xf
    v_add_f32_dpp v78, v78, v78 row_shr:4 row_mask:0xf bank_mask:0xf
    v_add_f32_dpp v79, v79, v79 row_shr:4 row_mask:0xf bank_mask:0xf
    s_waitcnt lgkmcnt(4)
    buffer_store_dwordx4 v[80:83], v92, s[24:27], s29 offen
    v_add_f32_dpp v76, v76, v76 row_shr:8 row_mask:0xf bank_mask:0xf
    v_add_f32_dpp v77, v77, v77 row_shr:8 row_mask:0xf bank_mask:0xf
    v_add_f32_dpp v78, v78, v78 row_shr:8 row_mask:0xf bank_mask:0xf
    v_add_f32_dpp v79, v79, v79 row_shr:8 row_mask:0xf bank_mask:0xf
    v_add_f32_dpp v76, v76, v76 row_bcast:15 row_mask:0xa bank_mask:0xf
    v_add_f32_dpp v77, v77, v77 row_bcast:15 row_mask:0xa bank_mask:0xf
    v_add_f32_dpp v78, v78, v78 row_bcast:15 row_mask:0xa bank_mask:0xf
    v_add_f32_dpp v79, v79, v79 row_bcast:15 row_mask:0xa bank_mask:0xf
    s_waitcnt lgkmcnt(0)
    buffer_store_dwordx4 v[84:87], v92, s[24:27], s28 offen
    v_add_f32_dpp v76, v76, v76 row_bcast:31 row_mask:0xc bank_mask:0xf
    v_add_f32_dpp v77, v77, v77 row_bcast:31 row_mask:0xc bank_mask:0xf
    v_add_f32_dpp v78, v78, v78 row_bcast:31 row_mask:0xc bank_mask:0xf
    v_add_f32_dpp v79, v79, v79 row_bcast:31 row_mask:0xc bank_mask:0xf
    s_mov_b32 exec_lo, 0
    s_mov_b32 exec_hi, 0x80000000
    buffer_store_dwordx2 v[76:77], v26, s[24:27], s18 offen
    buffer_store_dwordx2 v[78:79], v26, s[24:27], s19 offen
    s_mov_b64 exec, -1
    s_cmp_lt_u32 s7, 22
    s_cbranch_scc1 Lp_w8
    s_waitcnt vmcnt(5)
Lp_rs:
    ds_read_b64_tr_b16 v[32:33], v5 offset:0
    ds_read_b64_tr_b16 v[34:35], v5 offset:512
    ds_read_b64_tr_b16 v[36:37], v5 offset:32
    ds_read_b64_tr_b16 v[38:39], v5 offset:544
    ds_read_b64_tr_b16 v[40:41], v5 offset:64
    ds_read_b64_tr_b16 v[42:43], v5 offset:576
    ds_read_b64_tr_b16 v[44:45], v5 offset:96
    ds_read_b64_tr_b16 v[46:47], v5 offset:608
    s_waitcnt lgkmcnt(6)
    buffer_store_dwordx4 v[32:35], v4, s[24:27], s33 offen offset:0
    s_waitcnt lgkmcnt(4)
    buffer_store_dwordx4 v[36:39], v4, s[24:27], s33 offen offset:1024
    s_waitcnt lgkmcnt(2)
    buffer_store_dwordx4 v[40:43], v4, s[24:27], s33 offen offset:2048
    s_waitcnt lgkmcnt(0)
    buffer_store_dwordx4 v[44:47], v4, s[24:27], s33 offen offset:3072
    s_add_u32 s30, s30, 320
    v_add_u32 v5, 4096, v5
    s_add_u32 s33, s33, 163840
    s_cmp_lt_u32 s30, 352
    s_cbranch_scc1 Lp_rs
    s_branch Lp_end2
Lp_w8:
    s_cmp_ge_u32 s22, 172
    s_cbranch_scc1 Lp_end2
    s_waitcnt vmcnt(8)
    ds_read_b64_tr_b16 v[8:9], v7 offset:0
    ds_read_b64_tr_b16 v[10:11], v7 offset:512
    s_waitcnt vmcnt(7)
    ds_read_b64_tr_b16 v[12:13], v7 offset:1024
    ds_read_b64_tr_b16 v[14:15], v7 offset:1536
    s_waitcnt vmcnt(6)
    ds_read_b64_tr_b16 v[16:17], v7 offset:2048
    ds_read_b64_tr_b16 v[18:19], v7 offset:2560
    s_waitcnt vmcnt(5)
    ds_read_b64_tr_b16 v[20:21], v7 offset:3072
    ds_read_b64_tr_b16 v[22:23], v7 offset:3584
    s_waitcnt lgkmcnt(6)
    v_dot2c_f32_bf16 v72, s43, v8
    v_dot2c_f32_bf16 v73, s43, v9
    v_dot2c_f32_bf16 v72, s43, v10
    v_dot2c_f32_bf16 v73, s43, v11
    s_waitcnt lgkmcnt(4)
    v_dot2c_f32_bf16 v72, s43, v12
    v_dot2c_f32_bf16 v73, s43, v13
    v_dot2c_f32_bf16 v72, s43, v14
    v_dot2c_f32_bf16 v73, s43, v15
    s_waitcnt lgkmcnt(2)
    v_dot2c_f32_bf16 v72, s43, v16
    v_dot2c_f32_bf16 v73, s43, v17
    v_dot2c_f32_bf16 v72, s43, v18
    v_dot2c_f32_bf16 v73, s43, v19
    s_waitcnt lgkmcnt(0)
    v_dot2c_f32_bf16 v72, s43, v20
    v_dot2c_f32_bf16 v73, s43, v21
    v_dot2c_f32_bf16 v72, s43, v22
    v_dot2c_f32_bf16 v73, s43, v23
    v_lshlrev_b32 v32, 16, v8
    v_and_b32 v33, s44, v8
    v_lshlrev_b32 v34, 16, v9
    v_and_b32 v35, s44, v9
    v_add_f32 v72, v72, v73
    v_mov_b32 v73, v72
    v_lshlrev_b32 v36, 16, v10
    v_and_b32 v37, s44, v10
    v_permlane32_swap_b32 v72, v73
    v_add_f32 v72, v72, v73
    v_mov_b32 v73, v72
    v_lshlrev_b32 v38, 16, v11
    v_and_b32 v39, s44, v11
    v_permlane16_swap_b32 v72, v73
    v_add_f32 v72, v72, v73
    ds_write_b32 v5, v72
    v_lshlrev_b32 v40, 16, v12
    v_and_b32 v41, s44, v12
    v_lshlrev_b32 v42, 16, v13
    v_and_b32 v43, s44, v13
    v_lshlrev_b32 v44, 16, v14
    v_and_b32 v45, s44, v14
    v_lshlrev_b32 v46, 16, v15
    v_and_b32 v47, s44, v15
    v_lshlrev_b32 v48, 16, v16
    v_and_b32 v49, s44, v16
    v_lshlrev_b32 v50, 16, v17
    v_and_b32 v51, s44, v17
    v_lshlrev_b32 v52, 16, v18
    v_and_b32 v53, s44, v18
    v_lshlrev_b32 v54, 16, v19
    v_and_b32 v55, s44, v19
    v_lshlrev_b32 v56, 16, v20
    v_and_b32 v57, s44, v20
    v_lshlrev_b32 v58, 16, v21
    v_and_b32 v59, s44, v21
    v_lshlrev_b32 v60, 16, v22
    v_and_b32 v61, s44, v22
    v_lshlrev_b32 v62, 16, v23
    v_and_b32 v63, s44, v23
    s_waitcnt lgkmcnt(0)
    s_barrier
    ds_read_b128 v[24:27], v2
    s_waitcnt lgkmcnt(0)
    v_add_f32 v24, v24, v25
    v_add_f32 v26, v26, v27
    v_add_f32 v24, v24, v26
    v_mul_f32 v24, s40, v24
    v_pk_add_f32 v[32:33], v[32:33], v[24:25] op_sel_hi:[1,0]
    v_pk_add_f32 v[34:35], v[34:35], v[24:25] op_sel_hi:[1,0]
    v_pk_add_f32 v[36:37], v[36:37], v[24:25] op_sel_hi:[1,0]
    v_pk_add_f32 v[38:39], v[38:39], v[24:25] op_sel_hi:[1,0]
    v_cvt_pk_bf16_f32 v8, v32, v33
    v_cvt_pk_bf16_f32 v9, v34, v35
    v_cvt_pk_bf16_f32 v10, v36, v37
    v_cvt_pk_bf16_f32 v11, v38, v39
    buffer_store_dwordx4 v[8:11], v4, s[24:27], s32 offen offset:0
    v_pk_add_f32 v[40:41], v[40:41], v[24:25] op_sel_hi:[1,0]
    v_pk_add_f32 v[42:43], v[42:43], v[24:25] op_sel_hi:[1,0]
    v_pk_add_f32 v[44:45], v[44:45], v[24:25] op_sel_hi:[1,0]
    v_pk_add_f32 v[46:47], v[46:47], v[24:25] op_sel_hi:[1,0]
    v_cvt_pk_bf16_f32 v12, v40, v41
    v_cvt_pk_bf16_f32 v13, v42, v43
    v_cvt_pk_bf16_f32 v14, v44, v45
    v_cvt_pk_bf16_f32 v15, v46, v47
    buffer_store_dwordx4 v[12:15], v4, s[24:27], s32 offen offset:1024
    v_pk_add_f32 v[48:49], v[48:49], v[24:25] op_sel_hi:[1,0]
    v_pk_add_f32 v[50:51], v[50:51], v[24:25] op_sel_hi:[1,0]
    v_pk_add_f32 v[52:53], v[52:53], v[24:25] op_sel_hi:[1,0]
    v_pk_add_f32 v[54:55], v[54:55], v[24:25] op_sel_hi:[1,0]
    v_cvt_pk_bf16_f32 v16, v48, v49
    v_cvt_pk_bf16_f32 v17, v50, v51
    v_cvt_pk_bf16_f32 v18, v52, v53
    v_cvt_pk_bf16_f32 v19, v54, v55
    buffer_store_dwordx4 v[16:19], v4, s[24:27], s32 offen offset:2048
    v_pk_add_f32 v[56:57], v[56:57], v[24:25] op_sel_hi:[1,0]
    v_pk_add_f32 v[58:59], v[58:59], v[24:25] op_sel_hi:[1,0]
    v_pk_add_f32 v[60:61], v[60:61], v[24:25] op_sel_hi:[1,0]
    v_pk_add_f32 v[62:63], v[62:63], v[24:25] op_sel_hi:[1,0]
    v_cvt_pk_bf16_f32 v20, v56, v57
    v_cvt_pk_bf16_f32 v21, v58, v59
    v_cvt_pk_bf16_f32 v22, v60, v61
    v_cvt_pk_bf16_f32 v23, v62, v63
    buffer_store_dwordx4 v[20:23], v4, s[24:27], s32 offen offset:3072
Lp_end:
    s_endpgm
Lpf_start:
.globl main_kernel
.p2align 8
.type main_kernel,@function
main_kernel:
    s_cmp_ge_u32 s2, 512
    s_cbranch_scc1 Lm_end
    s_load_dwordx2 s[4:5], s[0:1], 104
    s_load_dwordx2 s[10:11], s[0:1], 88
    v_lshrrev_b32 v2, 6, v0
    v_and_b32 v1, 63, v0
    v_readfirstlane_b32 s3, v2
    v_lshlrev_b32 v1, 4, v1
    s_mov_b32 s14, 28835840
    s_mov_b32 s15, 0x20000
    s_mov_b32 s9, 262144
    s_mov_b32 s55, 1073741824
    s_cmp_ge_u32 s2, 256
    s_cbranch_scc1 Lu_role
    s_setprio 3
    s_and_b32 s6, s2, 7
    s_lshr_b32 s7, s2, 3
    s_lshl_b32 s17, s6, 5
    s_add_u32 s17, s17, s7
    s_lshr_b32 s29, s3, 1
    s_and_b32 s24, s3, 1
    s_lshl1_add_u32 s27, s17, s29
    s_mul_i32 s27, s27, 1312
    s_mul_i32 s28, s3, 2064
    s_add_u32 m0, s28, 16384
    s_lshl_b32 s19, s17, 13
    s_add_u32 s19, s19, 4259840
    s_mov_b32 s20, 25886720
    s_mov_b32 s21, 25894912
    s_add_u32 s22, s19, 4096
    s_mov_b32 s23, 25890816
    s_mov_b32 s25, 25899008
    v_and_b32 v40, 15, v0
    v_bfe_u32 v41, v0, 4, 2
    v_lshlrev_b32 v4, 4, v41
    v_lshl_add_u32 v4, v40, 6, v4
    s_lshl_b32 s43, s3, 10
    v_add_u32 v4, s43, v4
    s_lshl_b32 s42, s3, 12
    s_mov_b32 s40, 0x3b000000
    s_mov_b32 s41, s40
    s_mov_b32 s44, 0xffff0000
    v_mov_b32 v44, 0
    v_mov_b32 v45, 0
    v_mov_b32 v46, 0
    v_mov_b32 v47, 0
    v_bfe_u32 v42, v0, 5, 1
    v_mul_u32_u24 v42, 4096, v42
    v_add_u32 v42, v42, v1
    ds_write_b128 v42, v[44:47] offset:32768
    v_bfe_u32 v42, v0, 1, 3
    v_mul_u32_u24 v42, 4160, v42
    v_and_b32 v43, 16, v1
    v_add_u32 v42, v42, v43
    ds_write_b128 v42, v[44:47] offset:46080
    s_waitcnt lgkmcnt(0)
    s_mov_b32 s12, s4
    s_and_b32 s13, s5, 0xffff
    buffer_load_dwordx4 v1, s[12:15], s27 offen lds
    buffer_load_dwordx4 v1, s[12:15], s27 offen offset:1024 lds
    buffer_load_dwordx4 v[20:23], v4, s[12:15], s20 offen
    buffer_load_dwordx4 v[24:27], v4, s[12:15], s21 offen
    buffer_load_dwordx4 v[8:11], v4, s[12:15], s19 offen
    buffer_load_dwordx4 v[248:251], v4, s[12:15], s23 offen
    buffer_load_dwordx4 v[252:255], v4, s[12:15], s25 offen
    buffer_load_dwordx4 v[244:247], v4, s[12:15], s22 offen
    s_and_b32 s30, s7, 3
    s_lshl2_add_u32 s30, s6, s30
    s_lshr_b32 s31, s7, 2
    s_mul_i32 s35, s31, 44
    s_mul_i32 s26, s3, 11
    s_add_u32 s35, s35, s26
    s_lshl_b32 s35, s35, 12
    s_add_u32 s35, s35, 24444928
    v_and_b32 v48, 127, v0
    v_lshlrev_b32 v49, 3, v48
    v_sub_u32 v49, 1023, v49
    v_cvt_f32_u32 v50, v49
    v_mul_u32_u24 v49, 0x10001, v49
    s_sub_u32 s33, m0, 34048
    s_and_b32 s33, s33, 0xffff
    s_mul_i32 s33, s33, 0x10001
    s_mov_b32 s36, 1124090624
    s_add_u32 s37, m0, 2048
    v_mov_b32 v66, s37
    v_mov_b32 v67, s33
    ds_write_b32 v66, v44
    v_cmp_ne_u32 vcc, 127, v48
    s_mul_i32 s38, s29, 16640
    s_add_u32 s38, s38, 41984
    v_lshl_add_u32 v17, v48, 4, s38
    v_add_f32 v51, 0x80000000, v50
    v_add_f32 v52, 0xbf800000, v50
    v_add_u32 v53, 1115636352, v49
    v_cvt_pk_bf16_f32 v51, v51, v52
    v_pk_min_u16 v53, v53, s36
    v_pk_max_u16 v53, v53, v51
    v_pk_mad_u16 v53, v53, 2, v67 op_sel_hi:[1,0,1]
    v_and_b32 v54, 0xffff, v53
    v_lshrrev_b32 v55, 16, v53
    v_add_f32 v51, 0xc0000000, v50
    v_add_f32 v52, 0xc0400000, v50
    v_add_u32 v53, 1115505278, v49
    v_cvt_pk_bf16_f32 v51, v51, v52
    v_pk_min_u16 v53, v53, s36
    v_pk_max_u16 v53, v53, v51
    v_pk_mad_u16 v53, v53, 2, v67 op_sel_hi:[1,0,1]
    v_and_b32 v56, 0xffff, v53
    v_lshrrev_b32 v57, 16, v53
    v_add_f32 v51, 0xc0800000, v50
    v_add_f32 v52, 0xc0a00000, v50
    v_add_u32 v53, 1115374204, v49
    v_cvt_pk_bf16_f32 v51, v51, v52
    v_pk_min_u16 v53, v53, s36
    v_pk_max_u16 v53, v53, v51
    v_pk_mad_u16 v53, v53, 2, v67 op_sel_hi:[1,0,1]
    v_and_b32 v58, 0xffff, v53
    v_lshrrev_b32 v59, 16, v53
    v_add_f32 v51, 0xc0c00000, v50
    v_add_f32 v52, 0xc0e00000, v50
    v_add_u32 v53, 1115243130, v49
    v_cvt_pk_bf16_f32 v51, v51, v52
    v_pk_min_u16 v53, v53, s36
    v_pk_max_u16 v53, v53, v51
    v_pk_mad_u16 v53, v53, 2, v67 op_sel_hi:[1,0,1]
    v_and_b32 v60, 0xffff, v53
    v_lshrrev_b32 v61, 16, v53
    v_add_f32 v51, 0xc1000000, v50
    v_add_f32 v52, 0xc1100000, v50
    v_add_u32 v53, 1115112056, v49
    v_cvt_pk_bf16_f32 v51, v51, v52
    v_pk_min_u16 v53, v53, s36
    v_pk_max_u16 v53, v53, v51
    v_pk_mad_u16 v53, v53, 2, v67 op_sel_hi:[1,0,1]
    v_and_b32 v62, 0xffff, v53
    v_lshrrev_b32 v63, 16, v53
    v_add_f32 v51, 0xc1200000, v50
    v_add_f32 v52, 0xc1300000, v50
    v_add_u32 v53, 1114980982, v49
    v_cvt_pk_bf16_f32 v51, v51, v52
    v_pk_min_u16 v53, v53, s36
    v_pk_max_u16 v53, v53, v51
    v_pk_mad_u16 v53, v53, 2, v67 op_sel_hi:[1,0,1]
    v_and_b32 v64, 0xffff, v53
    v_cndmask_b32 v62, v66, v62, vcc
    v_cndmask_b32 v63, v66, v63, vcc
    v_cndmask_b32 v64, v66, v64, vcc
    s_add_u32 s37, m0, 1278
    v_lshlrev_b32 v18, 1, v48
    v_sub_u32 v16, s37, v18
    v_and_b32 v18, 2, v18
    v_sub_u32 v18, v16, v18
    v_add_u32 v19, -2, v16
    v_cndmask_b32 v19, v19, v16, vcc
    v_and_b32 v42, 3, v0
    v_sub_u32 v42, 3, v42
    v_mul_u32_u24 v42, 4160, v42
    v_bfe_u32 v43, v0, 2, 2
    v_lshl_add_u32 v2, v41, 1, v43
    v_lshlrev_b32 v2, 3, v2
    v_sub_u32 v2, v42, v2
    s_mul_i32 s28, s24, 16640
    s_lshl_b32 s26, s29, 8
    s_sub_u32 s28, s28, s26
    s_add_u32 s28, s28, 42312
    v_add_u32 v2, s28, v2
    v_lshlrev_b32 v3, 1, v40
    v_sub_u32 v3, v3, v41
    s_mul_i32 s28, s24, 4608
    s_sub_u32 s28, s28, s26
    s_add_u32 s28, s28, 33104
    v_lshl_add_u32 v3, v3, 4, s28
    v_and_b32 v6, 1, v0
    v_lshl_add_u32 v6, v43, 1, v6
    v_lshlrev_b32 v6, 15, v6
    v_and_b32 v42, 2, v0
    v_lshl_add_u32 v6, v42, 4, v6
    v_and_b32 v42, 16, v0
    v_lshl_add_u32 v6, v42, 2, v6
    v_and_b32 v42, 2, v41
    v_lshl_add_u32 v6, v42, 3, v6
    s_lshl_b32 s18, s3, 18
    s_lshl_b32 s28, s17, 7
    s_add_u32 s18, s18, s28
    s_add_u32 s18, s18, 8454144
    s_mul_i32 s46, s6, 69632
    s_mul_i32 s32, s2, 4352
    s_add_u32 s32, s32, 720896
    s_lshl2_add_u32 s46, s7, s46
    s_add_u32 s46, s46, s3
    s_add_u32 s48, s46, 721920
    s_add_u32 s46, s46, 721408
    s_mul_i32 s33, s3, 64
    s_add_u32 s33, s33, s2
    s_and_b32 s33, s33, 255
    s_mul_i32 s33, s33, 4352
    s_add_u32 s33, s33, 722432
    s_mov_b32 s16, 0
    s_lshr_b32 s45, s7, 1
    s_and_b32 s26, s6, 3
    s_or_b32 s26, s26, 12
    s_cmp_eq_u32 s45, s26
    s_cselect_b32 s45, 0, 0
    s_waitcnt vmcnt(6)
    ds_read_u16 v54, v54
    ds_read_u16 v55, v55
    ds_read_u16 v56, v56
    ds_read_u16 v57, v57
    ds_read_u16 v58, v58
    ds_read_u16 v59, v59
    ds_read_u16 v60, v60
    ds_read_u16 v61, v61
    ds_read_u16 v62, v62
    ds_read_u16 v63, v63
    ds_read_u16 v64, v64
    s_waitcnt vmcnt(5)
    v_mov_b32 v76, 0x3727c5ac
    v_pk_mul_f32 v[20:21], v[20:21], s[40:41]
    v_pk_mul_f32 v[22:23], v[22:23], s[40:41]
    v_pk_fma_f32 v[68:69], v[20:21], v[20:21], v[76:77] op_sel_hi:[1,1,0] neg_lo:[1,0,0] neg_hi:[1,0,0]
    v_pk_fma_f32 v[70:71], v[22:23], v[22:23], v[76:77] op_sel_hi:[1,1,0] neg_lo:[1,0,0] neg_hi:[1,0,0]
    s_waitcnt vmcnt(4)
    v_pk_fma_f32 v[24:25], v[24:25], s[40:41], v[68:69]
    v_pk_fma_f32 v[26:27], v[26:27], s[40:41], v[70:71]
    v_rsq_f32 v24, |v24|
    v_rsq_f32 v25, |v25|
    v_rsq_f32 v26, |v26|
    v_rsq_f32 v27, |v27|
    v_lshrrev_b32 v76, 1, v4
    s_waitcnt vmcnt(3)
    v_lshlrev_b32 v68, 16, v8
    v_lshlrev_b32 v69, 16, v9
    v_lshlrev_b32 v70, 16, v10
    v_lshlrev_b32 v71, 16, v11
    v_pk_mul_f32 v[20:21], v[20:21], v[24:25] neg_lo:[1,0] neg_hi:[1,0]
    v_pk_mul_f32 v[22:23], v[22:23], v[26:27] neg_lo:[1,0] neg_hi:[1,0]
    v_and_b32 v72, s44, v8
    v_and_b32 v73, s44, v9
    v_and_b32 v74, s44, v10
    v_and_b32 v75, s44, v11
    v_pk_fma_f32 v[68:69], v[68:69], v[24:25], v[20:21]
    v_pk_fma_f32 v[70:71], v[70:71], v[26:27], v[22:23]
    v_cvt_pk_bf16_f32 v68, v68, v69
    v_cvt_pk_bf16_f32 v69, v70, v71
    s_waitcnt lgkmcnt(3)
    v_lshl_or_b32 v36, v55, 16, v54
    v_lshl_or_b32 v37, v57, 16, v56
    v_lshl_or_b32 v38, v59, 16, v58
    v_lshl_or_b32 v39, v61, 16, v60
    ds_write_b128 v17, v[36:39] offset:2048
    s_waitcnt lgkmcnt(3)
    v_lshl_or_b32 v40, v56, 16, v55
    v_lshl_or_b32 v41, v58, 16, v57
    v_lshl_or_b32 v42, v60, 16, v59
    v_lshl_or_b32 v43, v62, 16, v61
    ds_write_b128 v17, v[40:43] offset:6208
    s_waitcnt lgkmcnt(3)
    v_lshl_or_b32 v44, v57, 16, v56
    v_lshl_or_b32 v45, v59, 16, v58
    v_lshl_or_b32 v46, v61, 16, v60
    v_lshl_or_b32 v47, v63, 16, v62
    ds_write_b128 v17, v[44:47] offset:10368
    s_waitcnt lgkmcnt(3)
    v_lshl_or_b32 v48, v58, 16, v57
    v_lshl_or_b32 v49, v60, 16, v59
    v_lshl_or_b32 v50, v62, 16, v61
    v_lshl_or_b32 v51, v64, 16, v63
    ds_write_b128 v17, v[48:51] offset:14528
    ds_write_b64 v76, v[68:69] offset:33280
    v_pk_fma_f32 v[72:73], v[72:73], v[24:25], v[20:21]
    v_pk_fma_f32 v[74:75], v[74:75], v[26:27], v[22:23]
    v_cvt_pk_bf16_f32 v72, v72, v73
    v_cvt_pk_bf16_f32 v73, v74, v75
    ds_write_b64 v76, v[72:73] offset:37888
    s_waitcnt lgkmcnt(0)
    s_barrier
Lc_layer:
    ds_read_b64 v[36:37], v2 offset:3776
    ds_read_b64 v[38:39], v2 offset:3784
    ds_read_b128 v[40:43], v3 offset:192
    ds_read_b128 v[44:47], v3 offset:704
    ds_read_b128 v[48:51], v3 offset:1728
    ds_read_b128 v[52:55], v3 offset:1216
    ds_read_b64 v[56:57], v2 offset:3264
    ds_read_b64 v[58:59], v2 offset:3272
    ds_read_b64 v[60:61], v2 offset:2752
    ds_read_b64 v[62:63], v2 offset:2760
    ds_read_b64 v[64:65], v2 offset:2240
    ds_read_b64 v[66:67], v2 offset:2248
    s_waitcnt lgkmcnt(9)
    v_mfma_f32_16x16x32_bf16 v[20:23], v[36:39], v[40:43], 0
    ds_read_b64 v[68:69], v2 offset:3712
    ds_read_b64 v[70:71], v2 offset:3720
    s_waitcnt lgkmcnt(10)
    v_mfma_f32_16x16x32_bf16 v[24:27], v[36:39], v[44:47], 0
    ds_read_b128 v[72:75], v3 offset:128
    ds_read_b128 v[76:79], v3 offset:640
    s_waitcnt lgkmcnt(11)
    v_mfma_f32_16x16x32_bf16 v[32:35], v[36:39], v[48:51], 0
    s_waitcnt lgkmcnt(10)
    v_mfma_f32_16x16x32_bf16 v[28:31], v[36:39], v[52:55], 0
    ds_read_b128 v[48:51], v3 offset:1664
    s_waitcnt lgkmcnt(9)
    v_mfma_f32_16x16x32_bf16 v[32:35], v[56:59], v[52:55], v[32:35]
    ds_read_b128 v[36:39], v3 offset:1152
    v_mfma_f32_16x16x32_bf16 v[24:27], v[56:59], v[40:43], v[24:27]
    ds_read_b64 v[52:53], v2 offset:3200
    ds_read_b64 v[54:55], v2 offset:3208
    v_mfma_f32_16x16x32_bf16 v[28:31], v[56:59], v[44:47], v[28:31]
    s_waitcnt lgkmcnt(10)
    v_mfma_f32_16x16x32_bf16 v[32:35], v[60:63], v[44:47], v[32:35]
    ds_read_b64 v[56:57], v2 offset:2688
    ds_read_b64 v[58:59], v2 offset:2696
    v_mfma_f32_16x16x32_bf16 v[28:31], v[60:63], v[40:43], v[28:31]
    ds_read_b64 v[44:45], v2 offset:2176
    ds_read_b64 v[46:47], v2 offset:2184
    s_waitcnt lgkmcnt(12)
    v_mfma_f32_16x16x32_bf16 v[32:35], v[64:67], v[40:43], v[32:35]
    ds_read_b64 v[60:61], v2 offset:3648
    ds_read_b64 v[62:63], v2 offset:3656
    s_waitcnt lgkmcnt(11)
    v_mfma_f32_16x16x32_bf16 v[20:23], v[68:71], v[72:75], v[20:23]
    ds_read_b128 v[64:67], v3 offset:64
    ds_read_b128 v[40:43], v3 offset:576
    s_waitcnt lgkmcnt(12)
    v_mfma_f32_16x16x32_bf16 v[24:27], v[68:71], v[76:79], v[24:27]
    s_waitcnt lgkmcnt(11)
    v_mfma_f32_16x16x32_bf16 v[32:35], v[68:71], v[48:51], v[32:35]
    s_waitcnt lgkmcnt(10)
    v_mfma_f32_16x16x32_bf16 v[28:31], v[68:71], v[36:39], v[28:31]
    ds_read_b128 v[48:51], v3 offset:1600
    s_waitcnt lgkmcnt(9)
    v_mfma_f32_16x16x32_bf16 v[32:35], v[52:55], v[36:39], v[32:35]
    ds_read_b128 v[68:71], v3 offset:1088
    v_mfma_f32_16x16x32_bf16 v[24:27], v[52:55], v[72:75], v[24:27]
    ds_read_b64 v[36:37], v2 offset:3136
    ds_read_b64 v[38:39], v2 offset:3144
    v_mfma_f32_16x16x32_bf16 v[28:31], v[52:55], v[76:79], v[28:31]
    s_waitcnt lgkmcnt(10)
    v_mfma_f32_16x16x32_bf16 v[32:35], v[56:59], v[76:79], v[32:35]
    ds_read_b64 v[52:53], v2 offset:2624
    ds_read_b64 v[54:55], v2 offset:2632
    v_mfma_f32_16x16x32_bf16 v[28:31], v[56:59], v[72:75], v[28:31]
    ds_read_b64 v[76:77], v2 offset:2112
    ds_read_b64 v[78:79], v2 offset:2120
    s_waitcnt lgkmcnt(12)
    v_mfma_f32_16x16x32_bf16 v[32:35], v[44:47], v[72:75], v[32:35]
    ds_read_b64 v[56:57], v2 offset:3584
    ds_read_b64 v[58:59], v2 offset:3592
    s_waitcnt lgkmcnt(11)
    v_mfma_f32_16x16x32_bf16 v[20:23], v[60:63], v[64:67], v[20:23]
    ds_read_b128 v[44:47], v3 offset:0
    ds_read_b128 v[72:75], v3 offset:512
    s_waitcnt lgkmcnt(12)
    v_mfma_f32_16x16x32_bf16 v[24:27], v[60:63], v[40:43], v[24:27]
    s_waitcnt lgkmcnt(11)
    v_mfma_f32_16x16x32_bf16 v[32:35], v[60:63], v[48:51], v[32:35]
    s_waitcnt lgkmcnt(10)
    v_mfma_f32_16x16x32_bf16 v[28:31], v[60:63], v[68:71], v[28:31]
    ds_read_b128 v[48:51], v3 offset:1536
    s_waitcnt lgkmcnt(9)
    v_mfma_f32_16x16x32_bf16 v[32:35], v[36:39], v[68:71], v[32:35]
    ds_read_b128 v[60:63], v3 offset:1024
    v_mfma_f32_16x16x32_bf16 v[24:27], v[36:39], v[64:67], v[24:27]
    ds_read_b64 v[68:69], v2 offset:3072
    ds_read_b64 v[70:71], v2 offset:3080
    v_mfma_f32_16x16x32_bf16 v[28:31], v[36:39], v[40:43], v[28:31]
    s_waitcnt lgkmcnt(10)
    v_mfma_f32_16x16x32_bf16 v[32:35], v[52:55], v[40:43], v[32:35]
    ds_read_b64 v[36:37], v2 offset:2560
    ds_read_b64 v[38:39], v2 offset:2568
    v_mfma_f32_16x16x32_bf16 v[28:31], v[52:55], v[64:67], v[28:31]
    ds_read_b64 v[40:41], v2 offset:2048
    ds_read_b64 v[42:43], v2 offset:2056
    s_waitcnt lgkmcnt(12)
    v_mfma_f32_16x16x32_bf16 v[32:35], v[76:79], v[64:67], v[32:35]
    s_waitcnt lgkmcnt(9)
    v_mfma_f32_16x16x32_bf16 v[20:23], v[56:59], v[44:47], v[20:23]
    s_waitcnt lgkmcnt(8)
    v_mfma_f32_16x16x32_bf16 v[24:27], v[56:59], v[72:75], v[24:27]
    s_waitcnt lgkmcnt(7)
    v_mfma_f32_16x16x32_bf16 v[32:35], v[56:59], v[48:51], v[32:35]
    s_waitcnt lgkmcnt(6)
    v_mfma_f32_16x16x32_bf16 v[28:31], v[56:59], v[60:63], v[28:31]
    s_waitcnt lgkmcnt(4)
    v_mfma_f32_16x16x32_bf16 v[32:35], v[68:71], v[60:63], v[32:35]
    v_mfma_f32_16x16x32_bf16 v[24:27], v[68:71], v[44:47], v[24:27]
    v_mfma_f32_16x16x32_bf16 v[28:31], v[68:71], v[72:75], v[28:31]
    s_waitcnt lgkmcnt(2)
    v_mfma_f32_16x16x32_bf16 v[32:35], v[36:39], v[72:75], v[32:35]
    v_mfma_f32_16x16x32_bf16 v[28:31], v[36:39], v[44:47], v[28:31]
    s_waitcnt lgkmcnt(0)
    v_mfma_f32_16x16x32_bf16 v[32:35], v[40:43], v[44:47], v[32:35]
    v_add_u32 v60, s42, v1
    v_add_u32 v61, s43, v1
    v_lshlrev_b32 v52, 16, v8
    v_and_b32 v56, s44, v8
    v_lshlrev_b32 v53, 16, v9
    v_and_b32 v57, s44, v9
    v_lshlrev_b32 v54, 16, v10
    v_and_b32 v58, s44, v10
    v_lshlrev_b32 v55, 16, v11
    v_and_b32 v59, s44, v11
    ds_write_b128 v60, v[20:23] offset:0
    ds_write_b128 v60, v[24:27] offset:1024
    ds_write_b128 v60, v[28:31] offset:2048
    ds_write_b128 v60, v[32:35] offset:3072
    s_cmp_eq_u32 s16, 0
    s_cbranch_scc1 Lc_h1
    s_mov_b64 exec, 1
    v_mov_b32 v0, -1
    buffer_store_byte v0, off, s[12:15], s46
    s_mov_b64 exec, -1
Lc_h1:
    s_waitcnt lgkmcnt(0)
    s_barrier
    ds_read_b128 v[36:39], v61 offset:0
    ds_read_b128 v[40:43], v61 offset:4096
    ds_read_b128 v[44:47], v61 offset:8192
    ds_read_b128 v[48:51], v61 offset:12288
    s_waitcnt lgkmcnt(3)
    v_pk_add_f32 v[52:53], v[52:53], v[36:37]
    v_pk_add_f32 v[54:55], v[54:55], v[38:39]
    s_waitcnt lgkmcnt(2)
    v_pk_add_f32 v[56:57], v[56:57], v[40:41]
    v_pk_add_f32 v[58:59], v[58:59], v[42:43]
    s_waitcnt lgkmcnt(1)
    v_pk_add_f32 v[52:53], v[52:53], v[44:45]
    v_pk_add_f32 v[54:55], v[54:55], v[46:47]
    v_cvt_pk_bf16_f32 v60, v52, v53
    v_cvt_pk_bf16_f32 v61, v54, v55
    s_waitcnt lgkmcnt(0)
    v_pk_add_f32 v[56:57], v[56:57], v[48:49]
    v_pk_add_f32 v[58:59], v[58:59], v[50:51]
    v_cvt_pk_bf16_f32 v62, v56, v57
    v_cvt_pk_bf16_f32 v63, v58, v59
    s_nop 0
    v_permlane16_swap_b32 v60, v62
    v_permlane16_swap_b32 v61, v63
    buffer_store_dwordx4 v[60:63], v6, s[12:15], s18 offen sc0 sc1
    s_add_u32 s18, s18, 1048576
    s_cmp_lg_u32 s16, 0
    s_cbranch_scc1 Lc_ab
    ds_read_u16 v36, v16 offset:2
    ds_read_u16 v37, v16
    ds_read_u16 v38, v18 offset:2
    ds_read_u16 v39, v19
    s_waitcnt vmcnt(1)
    v_mov_b32 v76, 0x3727c5ac
    v_pk_mul_f32 v[248:249], v[248:249], s[40:41]
    v_pk_mul_f32 v[250:251], v[250:251], s[40:41]
    v_pk_fma_f32 v[68:69], v[248:249], v[248:249], v[76:77] op_sel_hi:[1,1,0] neg_lo:[1,0,0] neg_hi:[1,0,0]
    v_pk_fma_f32 v[70:71], v[250:251], v[250:251], v[76:77] op_sel_hi:[1,1,0] neg_lo:[1,0,0] neg_hi:[1,0,0]
    v_pk_fma_f32 v[252:253], v[252:253], s[40:41], v[68:69]
    v_pk_fma_f32 v[254:255], v[254:255], s[40:41], v[70:71]
    v_rsq_f32 v252, |v252|
    v_rsq_f32 v253, |v253|
    v_rsq_f32 v254, |v254|
    v_rsq_f32 v255, |v255|
    v_lshrrev_b32 v76, 1, v4
    v_lshlrev_b32 v68, 16, v244
    v_lshlrev_b32 v69, 16, v245
    v_lshlrev_b32 v70, 16, v246
    v_lshlrev_b32 v71, 16, v247
    v_pk_mul_f32 v[248:249], v[248:249], v[252:253] neg_lo:[1,0] neg_hi:[1,0]
    v_pk_mul_f32 v[250:251], v[250:251], v[254:255] neg_lo:[1,0] neg_hi:[1,0]
    v_and_b32 v72, s44, v244
    v_and_b32 v73, s44, v245
    v_and_b32 v74, s44, v246
    v_and_b32 v75, s44, v247
    v_pk_fma_f32 v[68:69], v[68:69], v[252:253], v[248:249]
    v_pk_fma_f32 v[70:71], v[70:71], v[254:255], v[250:251]
    v_cvt_pk_bf16_f32 v68, v68, v69
    v_cvt_pk_bf16_f32 v69, v70, v71
    ds_write_b64 v76, v[68:69] offset:35328
    v_pk_fma_f32 v[72:73], v[72:73], v[252:253], v[248:249]
    v_pk_fma_f32 v[74:75], v[74:75], v[254:255], v[250:251]
    v_cvt_pk_bf16_f32 v72, v72, v73
    v_cvt_pk_bf16_f32 v73, v74, v75
    ds_write_b64 v76, v[72:73] offset:39936
    v_mov_b32 v8, v244
    v_mov_b32 v9, v245
    v_mov_b32 v10, v246
    v_mov_b32 v11, v247
    s_waitcnt lgkmcnt(2)
    v_lshl_or_b32 v40, v36, 16, v36
    v_lshl_or_b32 v41, v38, 16, v36
    v_lshl_or_b32 v42, v37, 16, v37
    v_mov_b32 v43, v42
    ds_write_b128 v17, v[40:43]
    v_mov_b32 v44, v40
    v_lshl_or_b32 v45, v37, 16, v38
    v_mov_b32 v46, v42
    v_mov_b32 v47, v42
    ds_write_b128 v17, v[44:47] offset:4160
    v_mov_b32 v48, v41
    v_mov_b32 v49, v42
    v_mov_b32 v50, v42
    v_mov_b32 v51, v42
    ds_write_b128 v17, v[48:51] offset:8320
    v_mov_b32 v52, v45
    v_mov_b32 v53, v42
    v_mov_b32 v54, v42
    v_lshl_or_b32 v55, v39, 16, v37
    ds_write_b128 v17, v[52:55] offset:12480
    s_waitcnt lgkmcnt(0)
    s_barrier
Lc_ab:
    s_mov_b64 s[28:29], 0
    s_mov_b64 s[58:59], -1
    s_cmp_eq_u32 s16, 0
    s_cselect_b32 s47, s55, s33
    s_mov_b32 s27, 1
    ds_read_b64 v[36:37], v2 offset:3264
    ds_read_b64 v[38:39], v2 offset:3272
    ds_read_b128 v[40:43], v3 offset:1728
    ds_read_b64 v[44:45], v2 offset:2752
    ds_read_b64 v[46:47], v2 offset:2760
    ds_read_b128 v[48:51], v3 offset:1216
    ds_read_b64 v[52:53], v2 offset:2240
    ds_read_b64 v[54:55], v2 offset:2248
    ds_read_b128 v[56:59], v3 offset:704
    ds_read_b64 v[60:61], v2 offset:1728
    ds_read_b64 v[62:63], v2 offset:1736
    ds_read_b128 v[64:67], v3 offset:192
    s_waitcnt lgkmcnt(9)
    v_mfma_f32_16x16x32_bf16 v[20:23], v[36:39], v[40:43], 0
    ds_read_b64 v[68:69], v2 offset:1216
    ds_read_b64 v[70:71], v2 offset:1224
    s_buffer_load_dwordx2 s[28:29], s[12:15], s47 glc
    s_waitcnt lgkmcnt(9)
    v_mfma_f32_16x16x32_bf16 v[24:27], v[44:47], v[40:43], 0
    ds_read_b64 v[72:73], v2 offset:704
    ds_read_b64 v[74:75], v2 offset:712
    s_waitcnt lgkmcnt(10)
    v_mfma_f32_16x16x32_bf16 v[20:23], v[44:47], v[48:51], v[20:23]
    ds_read_b64 v[76:77], v2 offset:192
    ds_read_b64 v[78:79], v2 offset:200
    s_waitcnt lgkmcnt(10)
    v_mfma_f32_16x16x32_bf16 v[28:31], v[52:55], v[40:43], 0
    ds_read_b64 v[36:37], v2 offset:3200
    ds_read_b64 v[38:39], v2 offset:3208
    v_mfma_f32_16x16x32_bf16 v[24:27], v[52:55], v[48:51], v[24:27]
    ds_read_b128 v[44:47], v3 offset:1664
    s_waitcnt lgkmcnt(12)
    v_mfma_f32_16x16x32_bf16 v[20:23], v[52:55], v[56:59], v[20:23]
    s_waitcnt lgkmcnt(10)
    v_mfma_f32_16x16x32_bf16 v[32:35], v[60:63], v[40:43], 0
    ds_read_b64 v[52:53], v2 offset:2688
    ds_read_b64 v[54:55], v2 offset:2696
    v_mfma_f32_16x16x32_bf16 v[28:31], v[60:63], v[48:51], v[28:31]
    ds_read_b128 v[40:43], v3 offset:1152
    v_mfma_f32_16x16x32_bf16 v[24:27], v[60:63], v[56:59], v[24:27]
    s_waitcnt lgkmcnt(12)
    v_mfma_f32_16x16x32_bf16 v[20:23], v[60:63], v[64:67], v[20:23]
    s_waitcnt lgkmcnt(10)
    v_mfma_f32_16x16x32_bf16 v[32:35], v[68:71], v[48:51], v[32:35]
    ds_read_b64 v[60:61], v2 offset:2176
    ds_read_b64 v[62:63], v2 offset:2184
    s_cmp_lg_u32 s16, 0
    s_cbranch_scc1 Lc_ax0
    s_waitcnt vmcnt(0)
    s_mov_b64 exec, 1
    v_mov_b32 v0, -1
    buffer_store_byte v0, off, s[12:15], s46
    s_mov_b64 exec, -1
Lc_ax0:
    v_mfma_f32_16x16x32_bf16 v[28:31], v[68:71], v[56:59], v[28:31]
    ds_read_b128 v[48:51], v3 offset:640
    v_mfma_f32_16x16x32_bf16 v[24:27], v[68:71], v[64:67], v[24:27]
    s_cmp_eq_u64 s[28:29], s[58:59]
    s_cbranch_scc1 Lc_pc12
Lc_pd12:
    s_waitcnt lgkmcnt(11)
    v_mfma_f32_16x16x32_bf16 v[32:35], v[72:75], v[56:59], v[32:35]
    ds_read_b64 v[68:69], v2 offset:1664
    ds_read_b64 v[70:71], v2 offset:1672
    v_mfma_f32_16x16x32_bf16 v[28:31], v[72:75], v[64:67], v[28:31]
    ds_read_b128 v[56:59], v3 offset:128
    s_waitcnt lgkmcnt(12)
    v_mfma_f32_16x16x32_bf16 v[32:35], v[76:79], v[64:67], v[32:35]
    ds_read_b64 v[72:73], v2 offset:1152
    ds_read_b64 v[74:75], v2 offset:1160
    s_waitcnt lgkmcnt(11)
    v_mfma_f32_16x16x32_bf16 v[20:23], v[36:39], v[44:47], v[20:23]
    ds_read_b64 v[76:77], v2 offset:640
    ds_read_b64 v[78:79], v2 offset:648
    s_buffer_load_dwordx2 s[28:29], s[12:15], s47 glc
    s_waitcnt lgkmcnt(11)
    v_mfma_f32_16x16x32_bf16 v[24:27], v[52:55], v[44:47], v[24:27]
    ds_read_b64 v[64:65], v2 offset:128
    ds_read_b64 v[66:67], v2 offset:136
    s_cmp_eq_u64 s[28:29], s[58:59]
    s_cbranch_scc1 Lc_pc17
Lc_pd17:
    s_waitcnt lgkmcnt(12)
    v_mfma_f32_16x16x32_bf16 v[20:23], v[52:55], v[40:43], v[20:23]
    ds_read_b64 v[36:37], v2 offset:3136
    ds_read_b64 v[38:39], v2 offset:3144
    s_waitcnt lgkmcnt(12)
    v_mfma_f32_16x16x32_bf16 v[28:31], v[60:63], v[44:47], v[28:31]
    ds_read_b128 v[52:55], v3 offset:1600
    v_mfma_f32_16x16x32_bf16 v[24:27], v[60:63], v[40:43], v[24:27]
    s_waitcnt lgkmcnt(12)
    v_mfma_f32_16x16x32_bf16 v[20:23], v[60:63], v[48:51], v[20:23]
    s_waitcnt lgkmcnt(10)
    v_mfma_f32_16x16x32_bf16 v[32:35], v[68:71], v[44:47], v[32:35]
    ds_read_b64 v[60:61], v2 offset:2624
    ds_read_b64 v[62:63], v2 offset:2632
    s_cmp_eq_u64 s[28:29], s[58:59]
    s_cbranch_scc1 Lc_pc22
Lc_pd22:
    v_mfma_f32_16x16x32_bf16 v[28:31], v[68:71], v[40:43], v[28:31]
    ds_read_b128 v[44:47], v3 offset:1088
    v_mfma_f32_16x16x32_bf16 v[24:27], v[68:71], v[48:51], v[24:27]
    s_waitcnt lgkmcnt(12)
    v_mfma_f32_16x16x32_bf16 v[20:23], v[68:71], v[56:59], v[20:23]
    s_waitcnt lgkmcnt(10)
    v_mfma_f32_16x16x32_bf16 v[32:35], v[72:75], v[40:43], v[32:35]
    ds_read_b64 v[68:69], v2 offset:2112
    ds_read_b64 v[70:71], v2 offset:2120
    v_mfma_f32_16x16x32_bf16 v[28:31], v[72:75], v[48:51], v[28:31]
    ds_read_b128 v[40:43], v3 offset:576
    s_cmp_eq_u64 s[28:29], s[58:59]
    s_cbranch_scc1 Lc_pc27
Lc_pd27:
    v_mfma_f32_16x16x32_bf16 v[24:27], v[72:75], v[56:59], v[24:27]
    s_waitcnt lgkmcnt(11)
    v_mfma_f32_16x16x32_bf16 v[32:35], v[76:79], v[48:51], v[32:35]
    ds_read_b64 v[72:73], v2 offset:1600
    ds_read_b64 v[74:75], v2 offset:1608
    v_mfma_f32_16x16x32_bf16 v[28:31], v[76:79], v[56:59], v[28:31]
    ds_read_b128 v[48:51], v3 offset:64
    s_cmp_lg_u32 s45, 0
    s_cbranch_scc1 Lc_wh1
    buffer_load_dwordx4 v[80:83], v1, s[12:15], s35 offen offset:0
    buffer_load_dwordx4 v[84:87], v1, s[12:15], s35 offen offset:1024
Lc_wh1:
    s_waitcnt lgkmcnt(12)
    v_mfma_f32_16x16x32_bf16 v[32:35], v[64:67], v[56:59], v[32:35]
    ds_read_b64 v[76:77], v2 offset:1088
    ds_read_b64 v[78:79], v2 offset:1096
    s_waitcnt lgkmcnt(11)
    v_mfma_f32_16x16x32_bf16 v[20:23], v[36:39], v[52:55], v[20:23]
    ds_read_b64 v[64:65], v2 offset:576
    ds_read_b64 v[66:67], v2 offset:584
    s_cmp_eq_u64 s[28:29], s[58:59]
    s_cbranch_scc1 Lc_pc32
Lc_pd32:
    s_buffer_load_dwordx2 s[28:29], s[12:15], s47 glc
    s_waitcnt lgkmcnt(11)
    v_mfma_f32_16x16x32_bf16 v[24:27], v[60:63], v[52:55], v[24:27]
    ds_read_b64 v[56:57], v2 offset:64
    ds_read_b64 v[58:59], v2 offset:72
    s_waitcnt lgkmcnt(12)
    v_mfma_f32_16x16x32_bf16 v[20:23], v[60:63], v[44:47], v[20:23]
    ds_read_b64 v[36:37], v2 offset:3072
    ds_read_b64 v[38:39], v2 offset:3080
    s_waitcnt lgkmcnt(12)
    v_mfma_f32_16x16x32_bf16 v[28:31], v[68:71], v[52:55], v[28:31]
    ds_read_b128 v[60:63], v3 offset:1536
    s_cmp_lg_u32 s45, 0
    s_cbranch_scc1 Lc_wh2
    buffer_load_dwordx4 v[88:91], v1, s[12:15], s35 offen offset:2048
    buffer_load_dwordx4 v[92:95], v1, s[12:15], s35 offen offset:3072
Lc_wh2:
    v_mfma_f32_16x16x32_bf16 v[24:27], v[68:71], v[44:47], v[24:27]
    s_waitcnt lgkmcnt(12)
    v_mfma_f32_16x16x32_bf16 v[20:23], v[68:71], v[40:43], v[20:23]
    s_cmp_eq_u64 s[28:29], s[58:59]
    s_cbranch_scc1 Lc_pc37
Lc_pd37:
    s_waitcnt lgkmcnt(10)
    v_mfma_f32_16x16x32_bf16 v[32:35], v[72:75], v[52:55], v[32:35]
    ds_read_b64 v[68:69], v2 offset:2560
    ds_read_b64 v[70:71], v2 offset:2568
    v_mfma_f32_16x16x32_bf16 v[28:31], v[72:75], v[44:47], v[28:31]
    ds_read_b128 v[52:55], v3 offset:1024
    v_mfma_f32_16x16x32_bf16 v[24:27], v[72:75], v[40:43], v[24:27]
    s_cmp_lg_u32 s45, 0
    s_cbranch_scc1 Lc_wh3
    s_add_u32 s35, s35, 4096
    buffer_load_dwordx4 v[96:99], v1, s[12:15], s35 offen offset:0
    buffer_load_dwordx4 v[100:103], v1, s[12:15], s35 offen offset:1024
Lc_wh3:
    s_waitcnt lgkmcnt(12)
    v_mfma_f32_16x16x32_bf16 v[20:23], v[72:75], v[48:51], v[20:23]
    s_waitcnt lgkmcnt(10)
    v_mfma_f32_16x16x32_bf16 v[32:35], v[76:79], v[44:47], v[32:35]
    ds_read_b64 v[72:73], v2 offset:2048
    ds_read_b64 v[74:75], v2 offset:2056
    s_cmp_eq_u64 s[28:29], s[58:59]
    s_cbranch_scc1 Lc_pc42
Lc_pd42:
    v_mfma_f32_16x16x32_bf16 v[28:31], v[76:79], v[40:43], v[28:31]
    ds_read_b128 v[44:47], v3 offset:512
    v_mfma_f32_16x16x32_bf16 v[24:27], v[76:79], v[48:51], v[24:27]
    s_waitcnt lgkmcnt(11)
    v_mfma_f32_16x16x32_bf16 v[32:35], v[64:67], v[40:43], v[32:35]
    ds_read_b64 v[76:77], v2 offset:1536
    ds_read_b64 v[78:79], v2 offset:1544
    s_cmp_lg_u32 s45, 0
    s_cbranch_scc1 Lc_wh4
    buffer_load_dwordx4 v[104:107], v1, s[12:15], s35 offen offset:2048
    buffer_load_dwordx4 v[108:111], v1, s[12:15], s35 offen offset:3072
Lc_wh4:
    v_mfma_f32_16x16x32_bf16 v[28:31], v[64:67], v[48:51], v[28:31]
    ds_read_b128 v[40:43], v3 offset:0
    s_waitcnt lgkmcnt(12)
    v_mfma_f32_16x16x32_bf16 v[32:35], v[56:59], v[48:51], v[32:35]
    ds_read_b64 v[64:65], v2 offset:1024
    ds_read_b64 v[66:67], v2 offset:1032
    s_cmp_eq_u64 s[28:29], s[58:59]
    s_cbranch_scc1 Lc_pc47
Lc_pd47:
    s_waitcnt lgkmcnt(11)
    v_mfma_f32_16x16x32_bf16 v[20:23], v[36:39], v[60:63], v[20:23]
    ds_read_b64 v[56:57], v2 offset:512
    ds_read_b64 v[58:59], v2 offset:520
    s_buffer_load_dwordx2 s[28:29], s[12:15], s47 glc
    s_waitcnt lgkmcnt(11)
    v_mfma_f32_16x16x32_bf16 v[24:27], v[68:71], v[60:63], v[24:27]
    ds_read_b64 v[48:49], v2 offset:0
    ds_read_b64 v[50:51], v2 offset:8
    s_waitcnt lgkmcnt(12)
    v_mfma_f32_16x16x32_bf16 v[20:23], v[68:71], v[52:55], v[20:23]
    s_cmp_lg_u32 s45, 0
    s_cbranch_scc1 Lc_wh5
    s_add_u32 s35, s35, 4096
    buffer_load_dwordx4 v[112:115], v1, s[12:15], s35 offen offset:0
    buffer_load_dwordx4 v[116:119], v1, s[12:15], s35 offen offset:1024
Lc_wh5:
    s_waitcnt lgkmcnt(10)
    v_mfma_f32_16x16x32_bf16 v[28:31], v[72:75], v[60:63], v[28:31]
    v_mfma_f32_16x16x32_bf16 v[24:27], v[72:75], v[52:55], v[24:27]
    s_cmp_eq_u64 s[28:29], s[58:59]
    s_cbranch_scc1 Lc_pc52
Lc_pd52:
    s_waitcnt lgkmcnt(9)
    v_mfma_f32_16x16x32_bf16 v[20:23], v[72:75], v[44:47], v[20:23]
    s_waitcnt lgkmcnt(7)
    v_mfma_f32_16x16x32_bf16 v[32:35], v[76:79], v[60:63], v[32:35]
    v_mfma_f32_16x16x32_bf16 v[28:31], v[76:79], v[52:55], v[28:31]
    s_cmp_lg_u32 s45, 0
    s_cbranch_scc1 Lc_wh6
    buffer_load_dwordx4 v[120:123], v1, s[12:15], s35 offen offset:2048
    buffer_load_dwordx4 v[124:127], v1, s[12:15], s35 offen offset:3072
Lc_wh6:
    v_mfma_f32_16x16x32_bf16 v[24:27], v[76:79], v[44:47], v[24:27]
    s_waitcnt lgkmcnt(6)
    v_mfma_f32_16x16x32_bf16 v[20:23], v[76:79], v[40:43], v[20:23]
    s_cmp_eq_u64 s[28:29], s[58:59]
    s_cbranch_scc1 Lc_pc57
Lc_pd57:
    s_waitcnt lgkmcnt(4)
    v_mfma_f32_16x16x32_bf16 v[32:35], v[64:67], v[52:55], v[32:35]
    v_mfma_f32_16x16x32_bf16 v[28:31], v[64:67], v[44:47], v[28:31]
    v_mfma_f32_16x16x32_bf16 v[24:27], v[64:67], v[40:43], v[24:27]
    s_cmp_lg_u32 s45, 0
    s_cbranch_scc1 Lc_wh7
    s_add_u32 s35, s35, 4096
    buffer_load_dwordx4 v[128:131], v1, s[12:15], s35 offen offset:0
    buffer_load_dwordx4 v[132:135], v1, s[12:15], s35 offen offset:1024
Lc_wh7:
    s_waitcnt lgkmcnt(2)
    v_mfma_f32_16x16x32_bf16 v[32:35], v[56:59], v[44:47], v[32:35]
    v_mfma_f32_16x16x32_bf16 v[28:31], v[56:59], v[40:43], v[28:31]
    s_cmp_eq_u64 s[28:29], s[58:59]
    s_cbranch_scc1 Lc_pc62
Lc_pd62:
    s_waitcnt lgkmcnt(0)
    v_mfma_f32_16x16x32_bf16 v[32:35], v[48:51], v[40:43], v[32:35]
    s_add_u32 s46, s46, 557056
    s_cmp_eq_u32 s16, 0
    s_cbranch_scc1 Lc_bb
    s_cmp_eq_u32 s58, 1
    s_cbranch_scc1 Lc_gb
    s_waitcnt lgkmcnt(0)
    s_cmp_eq_u64 s[28:29], -1
    s_cbranch_scc1 Lc_pbx
    s_branch Lc_pbe
Lc_pb:
    s_and_b32 s26, s9, 63
    s_cbranch_scc1 Lc_pbf
    s_mov_b64 exec, 1
    v_mov_b32 v12, 3
    buffer_atomic_umax v12, off, s[12:15], s32
    s_mov_b64 exec, -1
Lc_pbf:
Lc_pbe:
    s_buffer_load_dwordx2 s[56:57], s[12:15], s33 glc
    s_sub_u32 s9, s9, 1
    s_cmp_lt_i32 s9, 0
    s_waitcnt lgkmcnt(0)
    s_cbranch_scc1 Lc_pbx
    s_cmp_lg_u64 s[56:57], -1
    s_cbranch_scc1 Lc_pb
Lc_pbx:
    buffer_load_dwordx4 v[16:19], v4, s[12:15], s23 offen sc1
    buffer_load_dwordx4 v[12:15], v4, s[12:15], s25 offen sc1
    buffer_load_dwordx4 v[8:11], v4, s[12:15], s22 offen sc1
Lc_gb:
    s_waitcnt vmcnt(2)
    v_mov_b32 v76, 0x3727c5ac
    v_mul_f32 v16, s40, v16
    v_mul_f32 v17, s40, v17
    v_mul_f32 v18, s40, v18
    v_mul_f32 v19, s40, v19
    v_fma_f32 v68, -v16, v16, v76
    v_fma_f32 v69, -v17, v17, v76
    v_fma_f32 v70, -v18, v18, v76
    v_fma_f32 v71, -v19, v19, v76
    s_waitcnt vmcnt(1)
    v_fmac_f32 v68, s40, v12
    v_fmac_f32 v69, s40, v13
    v_fmac_f32 v70, s40, v14
    v_fmac_f32 v71, s40, v15
    v_rsq_f32 v12, |v68|
    v_rsq_f32 v13, |v69|
    v_rsq_f32 v14, |v70|
    v_rsq_f32 v15, |v71|
    v_lshrrev_b32 v76, 1, v4
    s_waitcnt vmcnt(0)
    v_lshlrev_b32 v68, 16, v8
    v_lshlrev_b32 v69, 16, v9
    v_lshlrev_b32 v70, 16, v10
    v_lshlrev_b32 v71, 16, v11
    v_and_b32 v72, s44, v8
    v_and_b32 v73, s44, v9
    v_and_b32 v74, s44, v10
    v_and_b32 v75, s44, v11
    v_mul_f32 v16, v16, v12
    v_mul_f32 v17, v17, v13
    v_mul_f32 v18, v18, v14
    v_mul_f32 v19, v19, v15
    v_fma_f32 v68, v68, v12, -v16
    v_fma_f32 v69, v69, v13, -v17
    v_fma_f32 v70, v70, v14, -v18
    v_fma_f32 v71, v71, v15, -v19
    v_cvt_pk_bf16_f32 v68, v68, v69
    v_cvt_pk_bf16_f32 v69, v70, v71
    ds_write_b64 v76, v[68:69] offset:35328
    v_fma_f32 v72, v72, v12, -v16
    v_fma_f32 v73, v73, v13, -v17
    v_fma_f32 v74, v74, v14, -v18
    v_fma_f32 v75, v75, v15, -v19
    v_cvt_pk_bf16_f32 v72, v72, v73
    v_cvt_pk_bf16_f32 v73, v74, v75
    ds_write_b64 v76, v[72:73] offset:39936
    s_waitcnt lgkmcnt(0)
    s_barrier
Lc_bb:
    ds_read_b64 v[36:37], v2 offset:3776
    ds_read_b64 v[38:39], v2 offset:3784
    ds_read_b128 v[40:43], v3 offset:2240
    ds_read_b128 v[44:47], v3 offset:2752
    ds_read_b128 v[48:51], v3 offset:3776
    ds_read_b128 v[52:55], v3 offset:3264
    ds_read_b64 v[56:57], v2 offset:3264
    ds_read_b64 v[58:59], v2 offset:3272
    ds_read_b64 v[60:61], v2 offset:2752
    ds_read_b64 v[62:63], v2 offset:2760
    ds_read_b64 v[64:65], v2 offset:2240
    ds_read_b64 v[66:67], v2 offset:2248
    s_waitcnt lgkmcnt(9)
    v_mfma_f32_16x16x32_bf16 v[20:23], v[36:39], v[40:43], v[20:23]
    ds_read_b64 v[68:69], v2 offset:3712
    ds_read_b64 v[70:71], v2 offset:3720
    s_waitcnt lgkmcnt(10)
    v_mfma_f32_16x16x32_bf16 v[24:27], v[36:39], v[44:47], v[24:27]
    ds_read_b128 v[72:75], v3 offset:2176
    ds_read_b128 v[76:79], v3 offset:2688
    s_waitcnt lgkmcnt(11)
    v_mfma_f32_16x16x32_bf16 v[32:35], v[36:39], v[48:51], v[32:35]
    s_waitcnt lgkmcnt(10)
    v_mfma_f32_16x16x32_bf16 v[28:31], v[36:39], v[52:55], v[28:31]
    ds_read_b128 v[48:51], v3 offset:3712
    s_waitcnt lgkmcnt(9)
    v_mfma_f32_16x16x32_bf16 v[32:35], v[56:59], v[52:55], v[32:35]
    ds_read_b128 v[36:39], v3 offset:3200
    v_mfma_f32_16x16x32_bf16 v[24:27], v[56:59], v[40:43], v[24:27]
    ds_read_b64 v[52:53], v2 offset:3200
    ds_read_b64 v[54:55], v2 offset:3208
    v_mfma_f32_16x16x32_bf16 v[28:31], v[56:59], v[44:47], v[28:31]
    s_waitcnt lgkmcnt(10)
    v_mfma_f32_16x16x32_bf16 v[32:35], v[60:63], v[44:47], v[32:35]
    ds_read_b64 v[56:57], v2 offset:2688
    ds_read_b64 v[58:59], v2 offset:2696
    v_mfma_f32_16x16x32_bf16 v[28:31], v[60:63], v[40:43], v[28:31]
    ds_read_b64 v[44:45], v2 offset:2176
    ds_read_b64 v[46:47], v2 offset:2184
    s_waitcnt lgkmcnt(12)
    v_mfma_f32_16x16x32_bf16 v[32:35], v[64:67], v[40:43], v[32:35]
    ds_read_b64 v[60:61], v2 offset:3648
    ds_read_b64 v[62:63], v2 offset:3656
    s_waitcnt lgkmcnt(11)
    v_mfma_f32_16x16x32_bf16 v[20:23], v[68:71], v[72:75], v[20:23]
    ds_read_b128 v[64:67], v3 offset:2112
    ds_read_b128 v[40:43], v3 offset:2624
    s_waitcnt lgkmcnt(12)
    v_mfma_f32_16x16x32_bf16 v[24:27], v[68:71], v[76:79], v[24:27]
    s_waitcnt lgkmcnt(11)
    v_mfma_f32_16x16x32_bf16 v[32:35], v[68:71], v[48:51], v[32:35]
    s_waitcnt lgkmcnt(10)
    v_mfma_f32_16x16x32_bf16 v[28:31], v[68:71], v[36:39], v[28:31]
    ds_read_b128 v[48:51], v3 offset:3648
    s_waitcnt lgkmcnt(9)
    v_mfma_f32_16x16x32_bf16 v[32:35], v[52:55], v[36:39], v[32:35]
    ds_read_b128 v[68:71], v3 offset:3136
    v_mfma_f32_16x16x32_bf16 v[24:27], v[52:55], v[72:75], v[24:27]
    ds_read_b64 v[36:37], v2 offset:3136
    ds_read_b64 v[38:39], v2 offset:3144
    v_mfma_f32_16x16x32_bf16 v[28:31], v[52:55], v[76:79], v[28:31]
    s_waitcnt lgkmcnt(10)
    v_mfma_f32_16x16x32_bf16 v[32:35], v[56:59], v[76:79], v[32:35]
    ds_read_b64 v[52:53], v2 offset:2624
    ds_read_b64 v[54:55], v2 offset:2632
    v_mfma_f32_16x16x32_bf16 v[28:31], v[56:59], v[72:75], v[28:31]
    ds_read_b64 v[76:77], v2 offset:2112
    ds_read_b64 v[78:79], v2 offset:2120
    s_waitcnt lgkmcnt(12)
    v_mfma_f32_16x16x32_bf16 v[32:35], v[44:47], v[72:75], v[32:35]
    ds_read_b64 v[56:57], v2 offset:3584
    ds_read_b64 v[58:59], v2 offset:3592
    s_waitcnt lgkmcnt(11)
    v_mfma_f32_16x16x32_bf16 v[20:23], v[60:63], v[64:67], v[20:23]
    ds_read_b128 v[44:47], v3 offset:2048
    ds_read_b128 v[72:75], v3 offset:2560
    s_waitcnt lgkmcnt(12)
    v_mfma_f32_16x16x32_bf16 v[24:27], v[60:63], v[40:43], v[24:27]
    s_waitcnt lgkmcnt(11)
    v_mfma_f32_16x16x32_bf16 v[32:35], v[60:63], v[48:51], v[32:35]
    s_waitcnt lgkmcnt(10)
    v_mfma_f32_16x16x32_bf16 v[28:31], v[60:63], v[68:71], v[28:31]
    ds_read_b128 v[48:51], v3 offset:3584
    s_cmp_eq_u32 s16, 0
    s_cbranch_scc1 Lc_h0
    s_mov_b64 exec, 1
    v_mov_b32 v0, -1
    buffer_store_byte v0, off, s[12:15], s46
    s_mov_b64 exec, -1
Lc_h0:
    s_waitcnt lgkmcnt(9)
    v_mfma_f32_16x16x32_bf16 v[32:35], v[36:39], v[68:71], v[32:35]
    ds_read_b128 v[60:63], v3 offset:3072
    v_mfma_f32_16x16x32_bf16 v[24:27], v[36:39], v[64:67], v[24:27]
    ds_read_b64 v[68:69], v2 offset:3072
    ds_read_b64 v[70:71], v2 offset:3080
    v_mfma_f32_16x16x32_bf16 v[28:31], v[36:39], v[40:43], v[28:31]
    s_waitcnt lgkmcnt(10)
    v_mfma_f32_16x16x32_bf16 v[32:35], v[52:55], v[40:43], v[32:35]
    ds_read_b64 v[36:37], v2 offset:2560
    ds_read_b64 v[38:39], v2 offset:2568
    v_mfma_f32_16x16x32_bf16 v[28:31], v[52:55], v[64:67], v[28:31]
    ds_read_b64 v[40:41], v2 offset:2048
    ds_read_b64 v[42:43], v2 offset:2056
    s_waitcnt lgkmcnt(12)
    v_mfma_f32_16x16x32_bf16 v[32:35], v[76:79], v[64:67], v[32:35]
    s_waitcnt lgkmcnt(9)
    v_mfma_f32_16x16x32_bf16 v[20:23], v[56:59], v[44:47], v[20:23]
    s_waitcnt lgkmcnt(8)
    v_mfma_f32_16x16x32_bf16 v[24:27], v[56:59], v[72:75], v[24:27]
    s_waitcnt lgkmcnt(7)
    v_mfma_f32_16x16x32_bf16 v[32:35], v[56:59], v[48:51], v[32:35]
    s_waitcnt lgkmcnt(6)
    v_mfma_f32_16x16x32_bf16 v[28:31], v[56:59], v[60:63], v[28:31]
    s_waitcnt lgkmcnt(4)
    v_mfma_f32_16x16x32_bf16 v[32:35], v[68:71], v[60:63], v[32:35]
    v_mfma_f32_16x16x32_bf16 v[24:27], v[68:71], v[44:47], v[24:27]
    v_mfma_f32_16x16x32_bf16 v[28:31], v[68:71], v[72:75], v[28:31]
    s_waitcnt lgkmcnt(2)
    v_mfma_f32_16x16x32_bf16 v[32:35], v[36:39], v[72:75], v[32:35]
    v_mfma_f32_16x16x32_bf16 v[28:31], v[36:39], v[44:47], v[28:31]
    s_waitcnt lgkmcnt(0)
    v_mfma_f32_16x16x32_bf16 v[32:35], v[40:43], v[44:47], v[32:35]
    v_add_u32 v60, s42, v1
    v_add_u32 v61, s43, v1
    v_lshlrev_b32 v52, 16, v8
    v_and_b32 v56, s44, v8
    v_lshlrev_b32 v53, 16, v9
    v_and_b32 v57, s44, v9
    v_lshlrev_b32 v54, 16, v10
    v_and_b32 v58, s44, v10
    v_lshlrev_b32 v55, 16, v11
    v_and_b32 v59, s44, v11
    ds_write_b128 v60, v[20:23] offset:0
    ds_write_b128 v60, v[24:27] offset:1024
    ds_write_b128 v60, v[28:31] offset:2048
    ds_write_b128 v60, v[32:35] offset:3072
    s_waitcnt lgkmcnt(0)
    s_barrier
    ds_read_b128 v[36:39], v61 offset:0
    ds_read_b128 v[40:43], v61 offset:4096
    ds_read_b128 v[44:47], v61 offset:8192
    ds_read_b128 v[48:51], v61 offset:12288
    s_waitcnt lgkmcnt(3)
    v_add_f32 v52, v52, v36
    v_add_f32 v53, v53, v37
    v_add_f32 v54, v54, v38
    v_add_f32 v55, v55, v39
    s_waitcnt lgkmcnt(2)
    v_add_f32 v56, v56, v40
    v_add_f32 v57, v57, v41
    v_add_f32 v58, v58, v42
    v_add_f32 v59, v59, v43
    s_waitcnt lgkmcnt(1)
    v_add_f32 v52, v52, v44
    v_add_f32 v53, v53, v45
    v_add_f32 v54, v54, v46
    v_add_f32 v55, v55, v47
    v_cvt_pk_bf16_f32 v60, v52, v53
    v_cvt_pk_bf16_f32 v61, v54, v55
    s_waitcnt lgkmcnt(0)
    v_add_f32 v56, v56, v48
    v_add_f32 v57, v57, v49
    v_add_f32 v58, v58, v50
    v_add_f32 v59, v59, v51
    v_cvt_pk_bf16_f32 v62, v56, v57
    v_cvt_pk_bf16_f32 v63, v58, v59
    s_nop 0
    v_permlane16_swap_b32 v60, v62
    v_permlane16_swap_b32 v61, v63
    buffer_store_dwordx4 v[60:63], v6, s[12:15], s18 offen sc0 sc1
    s_add_u32 s18, s18, 1048576
    s_cmp_lg_u32 s16, 0
    s_cbranch_scc1 Lc_d2set
    v_bfe_u32 v36, v1, 5, 3
    v_and_b32 v37, 16, v1
    v_lshrrev_b32 v38, 8, v1
    v_lshl_add_u32 v36, v38, 2, v36
    v_lshlrev_b32 v36, 4, v36
    v_lshl_add_u32 v36, v37, 3, v36
    v_and_b32 v36, 0xf0, v36
    v_lshl_add_u32 v36, v38, 8, v36
    s_lshl_b32 s26, s3, 13
    v_add_u32 v7, s26, v36
    s_lshl3_add_u32 s34, s30, s31
    s_mul_i32 s34, s34, 4352
    s_add_u32 s34, s34, 721152
    s_mul_i32 s50, s30, 92160
    s_mul_i32 s26, s3, 11264
    s_add_u32 s50, s50, s26
    s_add_u32 s50, s50, 12648448
    s_and_b32 s51, s30, 30
    s_lshl_b32 s51, s51, 15
    s_lshl_b32 s26, s31, 12
    s_add_u32 s51, s51, s26
    s_and_b32 s26, s30, 1
    s_lshl_b32 s26, s26, 5
    s_add_u32 s51, s51, s26
    s_add_u32 s51, s51, 8454144
    s_lshl_b32 s26, s30, 7
    s_add_u32 s52, s26, 25903104
    s_add_u32 s54, s26, 25919488
    s_lshl_b32 s53, s31, 18
    s_add_u32 s53, s53, s26
    s_add_u32 s53, s53, 6356992
    s_mov_b32 s49, 0
    s_add_u32 s19, s19, 2097152
    s_add_u32 s22, s22, 2097152
    s_mov_b32 s20, 25919488
    s_mov_b32 s21, 25927680
    s_mov_b32 s23, 25923584
    s_mov_b32 s25, 25931776
    v_lshrrev_b32 v36, 7, v1
    s_lshl_b32 s26, s3, 3
    v_add_u32 v36, s26, v36
    v_bfe_u32 v37, v1, 4, 3
    v_lshlrev_b32 v0, 4, v37
    v_lshl_add_u32 v15, v36, 13, v0
    s_branch Lc_dset
Lc_d2set:
    v_bfe_u32 v36, v1, 4, 5
    v_lshrrev_b32 v37, 9, v1
    s_lshl_b32 s26, s3, 1
    v_add_u32 v37, s26, v37
    v_lshlrev_b32 v0, 4, v37
    v_lshlrev_b32 v15, 2, v36
    v_lshl_add_u32 v15, v37, 12, v15
    s_lshl_b32 s53, s30, 15
    s_lshl_b32 s26, s31, 7
    s_add_u32 s53, s53, s26
Lc_dset:
    s_mov_b32 s36, s10
    s_and_b32 s37, s11, 0xffff
    s_mov_b32 s38, 2097152
    s_mov_b32 s39, 0x20000
    v_lshrrev_b32 v38, 2, v37
    v_and_b32 v39, 3, v37
    v_lshlrev_b32 v14, 3, v39
    v_lshl_add_u32 v14, v36, 7, v14
    v_lshl_add_u32 v14, v38, 15, v14
    v_and_b32 v40, 7, v36
    v_lshl_add_u32 v40, v39, 2, v40
    v_and_b32 v40, 15, v40
    v_lshl_add_u32 v40, v39, 4, v40
    v_lshrrev_b32 v41, 3, v36
    v_lshl_add_u32 v41, v38, 2, v41
    v_lshl_add_u32 v40, v41, 6, v40
    v_lshlrev_b32 v13, 4, v40
    s_cmp_lg_u32 s16, 0
    s_cbranch_scc1 Lc_h2
    s_waitcnt vmcnt(0)
    s_mov_b64 exec, 1
    v_mov_b32 v12, -1
    buffer_store_byte v12, off, s[12:15], s46
    s_mov_b64 exec, -1
Lc_h2:
    s_sub_u32 s46, s46, 556800
    s_add_u32 s47, s16, 1
    s_barrier
    s_setprio 0
    s_mov_b32 s24, s55
    s_mov_b32 s27, 0
    s_cmp_lg_u32 s16, 0
    s_cbranch_scc1 Lc_dpre
    s_cmp_eq_u32 s45, 0
    s_mov_b32 s45, 1
    s_cbranch_scc1 Lc_wr
    buffer_load_dwordx4 v[80:83], v1, s[12:15], s35 offen offset:0
    buffer_load_dwordx4 v[84:87], v1, s[12:15], s35 offen offset:1024
    buffer_load_dwordx4 v[88:91], v1, s[12:15], s35 offen offset:2048
    buffer_load_dwordx4 v[92:95], v1, s[12:15], s35 offen offset:3072
    s_add_u32 s35, s35, 4096
    buffer_load_dwordx4 v[96:99], v1, s[12:15], s35 offen offset:0
    buffer_load_dwordx4 v[100:103], v1, s[12:15], s35 offen offset:1024
    buffer_load_dwordx4 v[104:107], v1, s[12:15], s35 offen offset:2048
    buffer_load_dwordx4 v[108:111], v1, s[12:15], s35 offen offset:3072
    s_add_u32 s35, s35, 4096
    buffer_load_dwordx4 v[112:115], v1, s[12:15], s35 offen offset:0
    buffer_load_dwordx4 v[116:119], v1, s[12:15], s35 offen offset:1024
    buffer_load_dwordx4 v[120:123], v1, s[12:15], s35 offen offset:2048
    buffer_load_dwordx4 v[124:127], v1, s[12:15], s35 offen offset:3072
    s_add_u32 s35, s35, 4096
    buffer_load_dwordx4 v[128:131], v1, s[12:15], s35 offen offset:0
    buffer_load_dwordx4 v[132:135], v1, s[12:15], s35 offen offset:1024
Lc_wr:
    buffer_load_dwordx4 v[136:139], v1, s[12:15], s35 offen offset:2048
    buffer_load_dwordx4 v[140:143], v1, s[12:15], s35 offen offset:3072
    s_add_u32 s35, s35, 4096
    buffer_load_dwordx4 v[144:147], v1, s[12:15], s35 offen offset:0
    buffer_load_dwordx4 v[148:151], v1, s[12:15], s35 offen offset:1024
    buffer_load_dwordx4 v[152:155], v1, s[12:15], s35 offen offset:2048
    buffer_load_dwordx4 v[156:159], v1, s[12:15], s35 offen offset:3072
    s_waitcnt vmcnt(4)
    s_add_u32 s35, s35, 4096
    buffer_load_dwordx4 v[160:163], v1, s[12:15], s35 offen offset:0
    buffer_load_dwordx4 v[164:167], v1, s[12:15], s35 offen offset:1024
    s_waitcnt vmcnt(4)
    buffer_load_dwordx4 v[168:171], v1, s[12:15], s35 offen offset:2048
    buffer_load_dwordx4 v[172:175], v1, s[12:15], s35 offen offset:3072
    s_waitcnt vmcnt(4)
    s_add_u32 s35, s35, 4096
    buffer_load_dwordx4 v[176:179], v1, s[12:15], s35 offen offset:0
    buffer_load_dwordx4 v[180:183], v1, s[12:15], s35 offen offset:1024
    s_waitcnt vmcnt(4)
    buffer_load_dwordx4 v[184:187], v1, s[12:15], s35 offen offset:2048
    buffer_load_dwordx4 v[188:191], v1, s[12:15], s35 offen offset:3072
    s_waitcnt vmcnt(4)
    s_add_u32 s35, s35, 4096
    buffer_load_dwordx4 v[192:195], v1, s[12:15], s35 offen offset:0
    buffer_load_dwordx4 v[196:199], v1, s[12:15], s35 offen offset:1024
    s_waitcnt vmcnt(4)
    buffer_load_dwordx4 v[200:203], v1, s[12:15], s35 offen offset:2048
    buffer_load_dwordx4 v[204:207], v1, s[12:15], s35 offen offset:3072
    s_waitcnt vmcnt(4)
    s_add_u32 s35, s35, 4096
    buffer_load_dwordx4 v[208:211], v1, s[12:15], s35 offen offset:0
    buffer_load_dwordx4 v[212:215], v1, s[12:15], s35 offen offset:1024
    s_waitcnt vmcnt(4)
    buffer_load_dwordx4 v[216:219], v1, s[12:15], s35 offen offset:2048
    buffer_load_dwordx4 v[220:223], v1, s[12:15], s35 offen offset:3072
    s_waitcnt vmcnt(4)
    s_add_u32 s35, s35, 4096
    buffer_load_dwordx4 v[224:227], v1, s[12:15], s35 offen offset:0
    buffer_load_dwordx4 v[228:231], v1, s[12:15], s35 offen offset:1024
    s_waitcnt vmcnt(4)
    buffer_load_dwordx4 v[232:235], v1, s[12:15], s35 offen offset:2048
    buffer_load_dwordx4 v[236:239], v1, s[12:15], s35 offen offset:3072
    s_waitcnt vmcnt(4)
    s_add_u32 s35, s35, 4096
    buffer_load_dwordx4 v[240:243], v1, s[12:15], s35 offen offset:0
    buffer_load_dwordx4 v[244:247], v1, s[12:15], s35 offen offset:1024
    s_waitcnt vmcnt(4)
    buffer_load_dwordx4 v[248:251], v1, s[12:15], s35 offen offset:2048
    buffer_load_dwordx4 v[252:255], v1, s[12:15], s35 offen offset:3072
Lc_dpre:
    s_buffer_load_dwordx16 s[56:71], s[12:15], s34 glc
    s_mov_b64 s[28:29], 0
    s_mov_b32 s35, s55
Lc_dloop:
    s_cmp_eq_u32 s27, 0
    s_cbranch_scc1 Lc_w0e
    s_mov_b32 s27, 2
    s_waitcnt lgkmcnt(0)
    s_and_b64 s[4:5], s[56:57], s[58:59]
    s_and_b64 s[4:5], s[4:5], s[60:61]
    s_and_b64 s[4:5], s[4:5], s[62:63]
    s_and_b64 s[4:5], s[4:5], s[64:65]
    s_and_b64 s[4:5], s[4:5], s[66:67]
    s_and_b64 s[4:5], s[4:5], s[68:69]
    s_and_b64 s[4:5], s[4:5], s[70:71]
    s_and_b32 s4, s4, s5
    s_bitcmp1_b32 s4, s49
    s_cbranch_scc1 Lc_w0x
    s_buffer_load_dwordx16 s[56:71], s[12:15], s34 glc
    s_mov_b32 s27, 0
    s_waitcnt vmcnt(0)
    s_mov_b64 exec, 1
    v_mov_b32 v12, -1
    buffer_store_byte v12, off, s[12:15], s48
    s_mov_b64 exec, -1
    s_branch Lc_w0e
Lc_w0:
    s_and_b32 s26, s9, 63
    s_cbranch_scc1 Lc_w0f
    s_mov_b64 exec, 1
    v_mov_b32 v12, s47
    buffer_atomic_umax v12, off, s[12:15], s32
    s_mov_b64 exec, -1
Lc_w0f:
    s_buffer_load_dwordx16 s[56:71], s[12:15], s34 glc
Lc_w0e:
    s_sub_u32 s9, s9, 1
    s_cmp_lt_i32 s9, 0
    s_waitcnt lgkmcnt(0)
    s_cbranch_scc1 Lc_w0x
    s_and_b64 s[4:5], s[56:57], s[58:59]
    s_and_b64 s[4:5], s[4:5], s[60:61]
    s_and_b64 s[4:5], s[4:5], s[62:63]
    s_and_b64 s[4:5], s[4:5], s[64:65]
    s_and_b64 s[4:5], s[4:5], s[66:67]
    s_and_b64 s[4:5], s[4:5], s[68:69]
    s_and_b64 s[4:5], s[4:5], s[70:71]
    s_and_b32 s4, s4, s5
    s_bitcmp0_b32 s4, s49
    s_cbranch_scc1 Lc_w0
Lc_w0x:
    s_add_u32 s6, s50, 0
    buffer_load_dwordx4 v[36:39], v1, s[12:15], s6 offen offset:0 sc1
    buffer_load_dwordx4 v[40:43], v1, s[12:15], s6 offen offset:1024 sc1
    buffer_load_dwordx4 v[44:47], v1, s[12:15], s6 offen offset:2048 sc1
    buffer_load_dwordx4 v[48:51], v1, s[12:15], s6 offen offset:3072 sc1
    s_add_u32 s6, s50, 4096
    buffer_load_dwordx4 v[52:55], v1, s[12:15], s6 offen offset:0 sc1
    buffer_load_dwordx4 v[56:59], v1, s[12:15], s6 offen offset:1024 sc1
    buffer_load_dwordx4 v[60:63], v1, s[12:15], s6 offen offset:2048 sc1
    buffer_load_dwordx4 v[64:67], v1, s[12:15], s6 offen offset:3072 sc1
    s_add_u32 s6, s50, 8192
    buffer_load_dwordx4 v[68:71], v1, s[12:15], s6 offen offset:0 sc1
    buffer_load_dwordx4 v[72:75], v1, s[12:15], s6 offen offset:1024 sc1
    buffer_load_dwordx4 v[76:79], v1, s[12:15], s6 offen offset:2048 sc1
    buffer_load_dword v16, off, s[12:15], s55
    buffer_load_dword v16, off, s[12:15], s55
    buffer_load_dword v16, off, s[12:15], s55
    buffer_load_dword v16, off, s[12:15], s55
Lc_s0:
    s_add_u32 s49, s49, 1
    s_add_u32 s50, s50, 46080
    s_mov_b32 s7, 0
    s_bitcmp1_b32 s4, s49
    s_cbranch_scc1 Lc_t0
Lc_n0:
    s_buffer_load_dwordx16 s[56:71], s[12:15], s34 glc
    s_waitcnt vmcnt(14)
    s_cmp_eq_u32 s27, 2
    s_cbranch_scc0 Lc_nbn0
    s_mov_b32 s27, 0
    s_mov_b64 exec, 1
    v_mov_b32 v12, -1
    buffer_store_byte v12, off, s[12:15], s48
    s_mov_b64 exec, -1
Lc_nbn0:
    v_mfma_f32_16x16x32_bf16 v[20:23], v[36:39], v[80:83], 0
    v_mfma_f32_16x16x32_bf16 v[24:27], v[36:39], v[84:87], 0
    v_mfma_f32_16x16x32_bf16 v[28:31], v[36:39], v[88:91], 0
    v_mfma_f32_16x16x32_bf16 v[32:35], v[36:39], v[92:95], 0
    s_waitcnt vmcnt(13)
    v_mfma_f32_16x16x32_bf16 v[20:23], v[40:43], v[96:99], v[20:23]
    v_mfma_f32_16x16x32_bf16 v[24:27], v[40:43], v[100:103], v[24:27]
    v_mfma_f32_16x16x32_bf16 v[28:31], v[40:43], v[104:107], v[28:31]
    v_mfma_f32_16x16x32_bf16 v[32:35], v[40:43], v[108:111], v[32:35]
    s_waitcnt vmcnt(12)
    v_mfma_f32_16x16x32_bf16 v[20:23], v[44:47], v[112:115], v[20:23]
    v_mfma_f32_16x16x32_bf16 v[24:27], v[44:47], v[116:119], v[24:27]
    v_mfma_f32_16x16x32_bf16 v[28:31], v[44:47], v[120:123], v[28:31]
    v_mfma_f32_16x16x32_bf16 v[32:35], v[44:47], v[124:127], v[32:35]
    s_waitcnt vmcnt(11)
    v_mfma_f32_16x16x32_bf16 v[20:23], v[48:51], v[128:131], v[20:23]
    s_and_b64 s[4:5], s[56:57], s[58:59]
    s_and_b64 s[4:5], s[4:5], s[60:61]
    s_and_b64 s[4:5], s[4:5], s[62:63]
    s_and_b64 s[4:5], s[4:5], s[64:65]
    v_mfma_f32_16x16x32_bf16 v[24:27], v[48:51], v[132:135], v[24:27]
    s_and_b64 s[4:5], s[4:5], s[66:67]
    s_and_b64 s[4:5], s[4:5], s[68:69]
    s_and_b64 s[4:5], s[4:5], s[70:71]
    s_and_b32 s4, s4, s5
    v_mfma_f32_16x16x32_bf16 v[28:31], v[48:51], v[136:139], v[28:31]
    s_mov_b32 s7, 4
    s_bitcmp1_b32 s4, s49
    v_mfma_f32_16x16x32_bf16 v[32:35], v[48:51], v[140:143], v[32:35]
    s_cbranch_scc1 Lc_t0
    s_buffer_load_dwordx16 s[56:71], s[12:15], s34 glc
    s_waitcnt vmcnt(10)
    s_cmp_eq_u32 s27, 1
    s_cbranch_scc0 Lc_nbn4
    s_mov_b32 s27, 0
    s_waitcnt vmcnt(8)
    s_mov_b64 exec, 1
    v_mov_b32 v12, -1
    buffer_store_byte v12, off, s[12:15], s48
    s_mov_b64 exec, -1
Lc_nbn4:
    v_mfma_f32_16x16x32_bf16 v[20:23], v[52:55], v[144:147], v[20:23]
    v_mfma_f32_16x16x32_bf16 v[24:27], v[52:55], v[148:151], v[24:27]
    v_mfma_f32_16x16x32_bf16 v[28:31], v[52:55], v[152:155], v[28:31]
    v_mfma_f32_16x16x32_bf16 v[32:35], v[52:55], v[156:159], v[32:35]
    s_waitcnt vmcnt(9)
    v_mfma_f32_16x16x32_bf16 v[20:23], v[56:59], v[160:163], v[20:23]
    v_mfma_f32_16x16x32_bf16 v[24:27], v[56:59], v[164:167], v[24:27]
    v_mfma_f32_16x16x32_bf16 v[28:31], v[56:59], v[168:171], v[28:31]
    v_mfma_f32_16x16x32_bf16 v[32:35], v[56:59], v[172:175], v[32:35]
    s_waitcnt vmcnt(8)
    v_mfma_f32_16x16x32_bf16 v[20:23], v[60:63], v[176:179], v[20:23]
    v_mfma_f32_16x16x32_bf16 v[24:27], v[60:63], v[180:183], v[24:27]
    v_mfma_f32_16x16x32_bf16 v[28:31], v[60:63], v[184:187], v[28:31]
    v_mfma_f32_16x16x32_bf16 v[32:35], v[60:63], v[188:191], v[32:35]
    s_waitcnt vmcnt(7)
    v_mfma_f32_16x16x32_bf16 v[20:23], v[64:67], v[192:195], v[20:23]
    s_and_b64 s[4:5], s[56:57], s[58:59]
    s_and_b64 s[4:5], s[4:5], s[60:61]
    s_and_b64 s[4:5], s[4:5], s[62:63]
    s_and_b64 s[4:5], s[4:5], s[64:65]
    v_mfma_f32_16x16x32_bf16 v[24:27], v[64:67], v[196:199], v[24:27]
    s_and_b64 s[4:5], s[4:5], s[66:67]
    s_and_b64 s[4:5], s[4:5], s[68:69]
    s_and_b64 s[4:5], s[4:5], s[70:71]
    s_and_b32 s4, s4, s5
    v_mfma_f32_16x16x32_bf16 v[28:31], v[64:67], v[200:203], v[28:31]
    s_mov_b32 s7, 8
    s_bitcmp1_b32 s4, s49
    v_mfma_f32_16x16x32_bf16 v[32:35], v[64:67], v[204:207], v[32:35]
    s_cbranch_scc1 Lc_t0
    s_buffer_load_dwordx16 s[56:71], s[12:15], s34 glc
    s_waitcnt vmcnt(6)
    v_mfma_f32_16x16x32_bf16 v[20:23], v[68:71], v[208:211], v[20:23]
    v_mfma_f32_16x16x32_bf16 v[24:27], v[68:71], v[212:215], v[24:27]
    v_mfma_f32_16x16x32_bf16 v[28:31], v[68:71], v[216:219], v[28:31]
    v_mfma_f32_16x16x32_bf16 v[32:35], v[68:71], v[220:223], v[32:35]
    s_waitcnt vmcnt(5)
    v_mfma_f32_16x16x32_bf16 v[20:23], v[72:75], v[224:227], v[20:23]
    v_mfma_f32_16x16x32_bf16 v[24:27], v[72:75], v[228:231], v[24:27]
    v_mfma_f32_16x16x32_bf16 v[28:31], v[72:75], v[232:235], v[28:31]
    v_mfma_f32_16x16x32_bf16 v[32:35], v[72:75], v[236:239], v[32:35]
    s_waitcnt vmcnt(4)
    v_mfma_f32_16x16x32_bf16 v[20:23], v[76:79], v[240:243], v[20:23]
    v_mfma_f32_16x16x32_bf16 v[24:27], v[76:79], v[244:247], v[24:27]
    v_mfma_f32_16x16x32_bf16 v[28:31], v[76:79], v[248:251], v[28:31]
    v_mfma_f32_16x16x32_bf16 v[32:35], v[76:79], v[252:255], v[32:35]
    s_nop 4
    ds_write_b128 v7, v[20:23] offset:0
    ds_write_b128 v7, v[24:27] offset:1024
    ds_write_b128 v7, v[28:31] offset:2048
    ds_write_b128 v7, v[32:35] offset:3072
    s_cmp_eq_u32 s49, 1
    s_cbranch_scc1 Lc_fa0
Lc_fb0:
    s_branch Lc_w1e
Lc_g0_0:
    s_waitcnt vmcnt(17)
    s_cmp_eq_u32 s27, 2
    s_cbranch_scc0 Lc_nbg0
    s_mov_b32 s27, 0
    s_mov_b64 exec, 1
    v_mov_b32 v12, -1
    buffer_store_byte v12, off, s[12:15], s48
    s_mov_b64 exec, -1
Lc_nbg0:
    v_mfma_f32_16x16x32_bf16 v[20:23], v[36:39], v[80:83], 0
    v_mfma_f32_16x16x32_bf16 v[24:27], v[36:39], v[84:87], 0
    v_mfma_f32_16x16x32_bf16 v[28:31], v[36:39], v[88:91], 0
    v_mfma_f32_16x16x32_bf16 v[32:35], v[36:39], v[92:95], 0
    s_add_u32 s6, s50, 0
    buffer_load_dwordx4 v[36:39], v1, s[12:15], s6 offen offset:0 sc1
Lc_g0_1:
    s_waitcnt vmcnt(17)
    v_mfma_f32_16x16x32_bf16 v[20:23], v[40:43], v[96:99], v[20:23]
    v_mfma_f32_16x16x32_bf16 v[24:27], v[40:43], v[100:103], v[24:27]
    v_mfma_f32_16x16x32_bf16 v[28:31], v[40:43], v[104:107], v[28:31]
    v_mfma_f32_16x16x32_bf16 v[32:35], v[40:43], v[108:111], v[32:35]
    buffer_load_dwordx4 v[40:43], v1, s[12:15], s6 offen offset:1024 sc1
Lc_g0_2:
    s_waitcnt vmcnt(17)
    v_mfma_f32_16x16x32_bf16 v[20:23], v[44:47], v[112:115], v[20:23]
    v_mfma_f32_16x16x32_bf16 v[24:27], v[44:47], v[116:119], v[24:27]
    v_mfma_f32_16x16x32_bf16 v[28:31], v[44:47], v[120:123], v[28:31]
    v_mfma_f32_16x16x32_bf16 v[32:35], v[44:47], v[124:127], v[32:35]
    buffer_load_dwordx4 v[44:47], v1, s[12:15], s6 offen offset:2048 sc1
Lc_g0_3:
    s_waitcnt vmcnt(17)
    v_mfma_f32_16x16x32_bf16 v[20:23], v[48:51], v[128:131], v[20:23]
    v_mfma_f32_16x16x32_bf16 v[24:27], v[48:51], v[132:135], v[24:27]
    v_mfma_f32_16x16x32_bf16 v[28:31], v[48:51], v[136:139], v[28:31]
    v_mfma_f32_16x16x32_bf16 v[32:35], v[48:51], v[140:143], v[32:35]
    buffer_load_dwordx4 v[48:51], v1, s[12:15], s6 offen offset:3072 sc1
Lc_g0_4:
    s_buffer_load_dwordx16 s[56:71], s[12:15], s34 glc
    s_waitcnt vmcnt(17)
    s_cmp_eq_u32 s27, 1
    s_cbranch_scc0 Lc_nbg4
    s_mov_b32 s27, 0
    s_waitcnt vmcnt(15)
    s_mov_b64 exec, 1
    v_mov_b32 v12, -1
    buffer_store_byte v12, off, s[12:15], s48
    s_mov_b64 exec, -1
Lc_nbg4:
    v_mfma_f32_16x16x32_bf16 v[20:23], v[52:55], v[144:147], v[20:23]
    v_mfma_f32_16x16x32_bf16 v[24:27], v[52:55], v[148:151], v[24:27]
    v_mfma_f32_16x16x32_bf16 v[28:31], v[52:55], v[152:155], v[28:31]
    v_mfma_f32_16x16x32_bf16 v[32:35], v[52:55], v[156:159], v[32:35]
    s_add_u32 s6, s50, 4096
    buffer_load_dwordx4 v[52:55], v1, s[12:15], s6 offen offset:0 sc1
Lc_g0_5:
    s_waitcnt vmcnt(17)
    v_mfma_f32_16x16x32_bf16 v[20:23], v[56:59], v[160:163], v[20:23]
    v_mfma_f32_16x16x32_bf16 v[24:27], v[56:59], v[164:167], v[24:27]
    v_mfma_f32_16x16x32_bf16 v[28:31], v[56:59], v[168:171], v[28:31]
    v_mfma_f32_16x16x32_bf16 v[32:35], v[56:59], v[172:175], v[32:35]
    buffer_load_dwordx4 v[56:59], v1, s[12:15], s6 offen offset:1024 sc1
Lc_g0_6:
    s_waitcnt vmcnt(17)
    v_mfma_f32_16x16x32_bf16 v[20:23], v[60:63], v[176:179], v[20:23]
    v_mfma_f32_16x16x32_bf16 v[24:27], v[60:63], v[180:183], v[24:27]
    v_mfma_f32_16x16x32_bf16 v[28:31], v[60:63], v[184:187], v[28:31]
    v_mfma_f32_16x16x32_bf16 v[32:35], v[60:63], v[188:191], v[32:35]
    buffer_load_dwordx4 v[60:63], v1, s[12:15], s6 offen offset:2048 sc1
Lc_g0_7:
    s_waitcnt vmcnt(17)
    v_mfma_f32_16x16x32_bf16 v[20:23], v[64:67], v[192:195], v[20:23]
    v_mfma_f32_16x16x32_bf16 v[24:27], v[64:67], v[196:199], v[24:27]
    v_mfma_f32_16x16x32_bf16 v[28:31], v[64:67], v[200:203], v[28:31]
    v_mfma_f32_16x16x32_bf16 v[32:35], v[64:67], v[204:207], v[32:35]
    buffer_load_dwordx4 v[64:67], v1, s[12:15], s6 offen offset:3072 sc1
Lc_g0_8:
    s_waitcnt vmcnt(17)
    v_mfma_f32_16x16x32_bf16 v[20:23], v[68:71], v[208:211], v[20:23]
    v_mfma_f32_16x16x32_bf16 v[24:27], v[68:71], v[212:215], v[24:27]
    v_mfma_f32_16x16x32_bf16 v[28:31], v[68:71], v[216:219], v[28:31]
    v_mfma_f32_16x16x32_bf16 v[32:35], v[68:71], v[220:223], v[32:35]
    s_add_u32 s6, s50, 8192
    buffer_load_dwordx4 v[68:71], v1, s[12:15], s6 offen offset:0 sc1
Lc_g0_9:
    s_waitcnt vmcnt(17)
    v_mfma_f32_16x16x32_bf16 v[20:23], v[72:75], v[224:227], v[20:23]
    v_mfma_f32_16x16x32_bf16 v[24:27], v[72:75], v[228:231], v[24:27]
    v_mfma_f32_16x16x32_bf16 v[28:31], v[72:75], v[232:235], v[28:31]
    v_mfma_f32_16x16x32_bf16 v[32:35], v[72:75], v[236:239], v[32:35]
    buffer_load_dwordx4 v[72:75], v1, s[12:15], s6 offen offset:1024 sc1
Lc_g0_10:
    s_waitcnt vmcnt(17)
    v_mfma_f32_16x16x32_bf16 v[20:23], v[76:79], v[240:243], v[20:23]
    s_and_b64 s[4:5], s[56:57], s[58:59]
    s_and_b64 s[4:5], s[4:5], s[60:61]
    s_and_b64 s[4:5], s[4:5], s[62:63]
    v_mfma_f32_16x16x32_bf16 v[24:27], v[76:79], v[244:247], v[24:27]
    s_and_b64 s[4:5], s[4:5], s[64:65]
    s_and_b64 s[4:5], s[4:5], s[66:67]
    s_and_b64 s[4:5], s[4:5], s[68:69]
    v_mfma_f32_16x16x32_bf16 v[28:31], v[76:79], v[248:251], v[28:31]
    s_and_b64 s[4:5], s[4:5], s[70:71]
    s_and_b32 s4, s4, s5
    v_mfma_f32_16x16x32_bf16 v[32:35], v[76:79], v[252:255], v[32:35]
    buffer_load_dwordx4 v[76:79], v1, s[12:15], s6 offen offset:2048 sc1
    ds_write_b128 v7, v[20:23] offset:0
    ds_write_b128 v7, v[24:27] offset:1024
    s_nop 1
    ds_write_b128 v7, v[28:31] offset:2048
    s_nop 1
    ds_write_b128 v7, v[32:35] offset:3072
    s_cmp_eq_u32 s49, 1
    s_cbranch_scc1 Lc_fa1
Lc_fb1:
    s_branch Lc_s1
Lc_w1:
    s_and_b32 s26, s9, 63
    s_cbranch_scc1 Lc_w1f
    s_mov_b64 exec, 1
    v_mov_b32 v12, s47
    buffer_atomic_umax v12, off, s[12:15], s32
    s_mov_b64 exec, -1
Lc_w1f:
    s_buffer_load_dwordx16 s[56:71], s[12:15], s34 glc
Lc_w1e:
    s_sub_u32 s9, s9, 1
    s_cmp_lt_i32 s9, 0
    s_waitcnt lgkmcnt(0)
    s_cbranch_scc1 Lc_w1x
    s_and_b64 s[4:5], s[56:57], s[58:59]
    s_and_b64 s[4:5], s[4:5], s[60:61]
    s_and_b64 s[4:5], s[4:5], s[62:63]
    s_and_b64 s[4:5], s[4:5], s[64:65]
    s_and_b64 s[4:5], s[4:5], s[66:67]
    s_and_b64 s[4:5], s[4:5], s[68:69]
    s_and_b64 s[4:5], s[4:5], s[70:71]
    s_and_b32 s4, s4, s5
    s_bitcmp0_b32 s4, s49
    s_cbranch_scc1 Lc_w1
Lc_w1x:
    s_mov_b32 s7, 11
Lc_t0:
    buffer_load_dwordx2 v[16:17], v14, s[12:15], s51 offen sc1
    buffer_load_dwordx2 v[18:19], v14, s[12:15], s51 offen offset:64 sc1
    buffer_load_dwordx4 v[8:11], v0, s[12:15], s52 offen sc1
    s_cmp_eq_u32 s7, 0
    s_cbranch_scc1 Lc_g0_0
    s_add_u32 s6, s50, 0
    buffer_load_dwordx4 v[36:39], v1, s[12:15], s6 offen offset:0 sc1
    buffer_load_dwordx4 v[40:43], v1, s[12:15], s6 offen offset:1024 sc1
    buffer_load_dwordx4 v[44:47], v1, s[12:15], s6 offen offset:2048 sc1
    buffer_load_dwordx4 v[48:51], v1, s[12:15], s6 offen offset:3072 sc1
    s_cmp_eq_u32 s7, 4
    s_cbranch_scc1 Lc_g0_4
    s_add_u32 s6, s50, 4096
    buffer_load_dwordx4 v[52:55], v1, s[12:15], s6 offen offset:0 sc1
    buffer_load_dwordx4 v[56:59], v1, s[12:15], s6 offen offset:1024 sc1
    buffer_load_dwordx4 v[60:63], v1, s[12:15], s6 offen offset:2048 sc1
    buffer_load_dwordx4 v[64:67], v1, s[12:15], s6 offen offset:3072 sc1
    s_cmp_eq_u32 s7, 8
    s_cbranch_scc1 Lc_g0_8
    s_add_u32 s6, s50, 8192
    buffer_load_dwordx4 v[68:71], v1, s[12:15], s6 offen offset:0 sc1
    buffer_load_dwordx4 v[72:75], v1, s[12:15], s6 offen offset:1024 sc1
    buffer_load_dwordx4 v[76:79], v1, s[12:15], s6 offen offset:2048 sc1
Lc_s1:
    s_add_u32 s49, s49, 1
    s_add_u32 s50, s50, 2903040
    s_mov_b32 s7, 0
    s_bitcmp1_b32 s4, s49
    s_cbranch_scc1 Lc_t1
    s_mov_b32 s24, s55
    s_cmp_eq_u32 s49, 4
    s_cselect_b32 s35, s33, s55
    s_bitcmp1_b32 s49, 1
    s_cselect_b32 s8, s34, s55
Lc_n1:
    s_buffer_load_dwordx16 s[56:71], s[12:15], s8 glc
    s_waitcnt vmcnt(10)
    v_mfma_f32_16x16x32_bf16 v[20:23], v[36:39], v[80:83], 0
    v_mfma_f32_16x16x32_bf16 v[24:27], v[36:39], v[84:87], 0
    v_mfma_f32_16x16x32_bf16 v[28:31], v[36:39], v[88:91], 0
    v_mfma_f32_16x16x32_bf16 v[32:35], v[36:39], v[92:95], 0
    s_waitcnt vmcnt(9)
    v_mfma_f32_16x16x32_bf16 v[20:23], v[40:43], v[96:99], v[20:23]
    v_mfma_f32_16x16x32_bf16 v[24:27], v[40:43], v[100:103], v[24:27]
    v_mfma_f32_16x16x32_bf16 v[28:31], v[40:43], v[104:107], v[28:31]
    v_mfma_f32_16x16x32_bf16 v[32:35], v[40:43], v[108:111], v[32:35]
    s_waitcnt vmcnt(8)
    v_mfma_f32_16x16x32_bf16 v[20:23], v[44:47], v[112:115], v[20:23]
    v_mfma_f32_16x16x32_bf16 v[24:27], v[44:47], v[116:119], v[24:27]
    v_mfma_f32_16x16x32_bf16 v[28:31], v[44:47], v[120:123], v[28:31]
    v_mfma_f32_16x16x32_bf16 v[32:35], v[44:47], v[124:127], v[32:35]
    s_waitcnt vmcnt(7)
    v_mfma_f32_16x16x32_bf16 v[20:23], v[48:51], v[128:131], v[20:23]
    s_and_b64 s[4:5], s[56:57], s[58:59]
    s_and_b64 s[4:5], s[4:5], s[60:61]
    s_and_b64 s[4:5], s[4:5], s[62:63]
    s_and_b64 s[4:5], s[4:5], s[64:65]
    v_mfma_f32_16x16x32_bf16 v[24:27], v[48:51], v[132:135], v[24:27]
    s_and_b64 s[4:5], s[4:5], s[66:67]
    s_and_b64 s[4:5], s[4:5], s[68:69]
    s_and_b64 s[4:5], s[4:5], s[70:71]
    s_and_b32 s4, s4, s5
    v_mfma_f32_16x16x32_bf16 v[28:31], v[48:51], v[136:139], v[28:31]
    s_mov_b32 s7, 4
    s_bitcmp1_b32 s4, s49
    v_mfma_f32_16x16x32_bf16 v[32:35], v[48:51], v[140:143], v[32:35]
    s_cbranch_scc1 Lc_t1
    s_buffer_load_dwordx16 s[56:71], s[12:15], s8 glc
    s_waitcnt vmcnt(6)
    v_mfma_f32_16x16x32_bf16 v[20:23], v[52:55], v[144:147], v[20:23]
    v_mfma_f32_16x16x32_bf16 v[24:27], v[52:55], v[148:151], v[24:27]
    v_mfma_f32_16x16x32_bf16 v[28:31], v[52:55], v[152:155], v[28:31]
    v_mfma_f32_16x16x32_bf16 v[32:35], v[52:55], v[156:159], v[32:35]
    s_waitcnt vmcnt(5)
    v_mfma_f32_16x16x32_bf16 v[20:23], v[56:59], v[160:163], v[20:23]
    v_mfma_f32_16x16x32_bf16 v[24:27], v[56:59], v[164:167], v[24:27]
    v_mfma_f32_16x16x32_bf16 v[28:31], v[56:59], v[168:171], v[28:31]
    v_mfma_f32_16x16x32_bf16 v[32:35], v[56:59], v[172:175], v[32:35]
    s_waitcnt vmcnt(4)
    v_mfma_f32_16x16x32_bf16 v[20:23], v[60:63], v[176:179], v[20:23]
    v_mfma_f32_16x16x32_bf16 v[24:27], v[60:63], v[180:183], v[24:27]
    v_mfma_f32_16x16x32_bf16 v[28:31], v[60:63], v[184:187], v[28:31]
    v_mfma_f32_16x16x32_bf16 v[32:35], v[60:63], v[188:191], v[32:35]
    s_buffer_load_dwordx2 s[28:29], s[12:15], s35 glc
    s_waitcnt vmcnt(3)
    v_mfma_f32_16x16x32_bf16 v[20:23], v[64:67], v[192:195], v[20:23]
    s_and_b64 s[4:5], s[56:57], s[58:59]
    s_and_b64 s[4:5], s[4:5], s[60:61]
    s_and_b64 s[4:5], s[4:5], s[62:63]
    s_and_b64 s[4:5], s[4:5], s[64:65]
    v_mfma_f32_16x16x32_bf16 v[24:27], v[64:67], v[196:199], v[24:27]
    s_and_b64 s[4:5], s[4:5], s[66:67]
    s_and_b64 s[4:5], s[4:5], s[68:69]
    s_and_b64 s[4:5], s[4:5], s[70:71]
    s_and_b32 s4, s4, s5
    v_mfma_f32_16x16x32_bf16 v[28:31], v[64:67], v[200:203], v[28:31]
    s_mov_b32 s7, 8
    s_bitcmp1_b32 s4, s49
    v_mfma_f32_16x16x32_bf16 v[32:35], v[64:67], v[204:207], v[32:35]
    s_cbranch_scc1 Lc_t1
    s_waitcnt vmcnt(2)
    v_mfma_f32_16x16x32_bf16 v[20:23], v[68:71], v[208:211], v[20:23]
    v_mfma_f32_16x16x32_bf16 v[24:27], v[68:71], v[212:215], v[24:27]
    v_mfma_f32_16x16x32_bf16 v[28:31], v[68:71], v[216:219], v[28:31]
    v_mfma_f32_16x16x32_bf16 v[32:35], v[68:71], v[220:223], v[32:35]
    s_waitcnt vmcnt(1)
    v_mfma_f32_16x16x32_bf16 v[20:23], v[72:75], v[224:227], v[20:23]
    v_mfma_f32_16x16x32_bf16 v[24:27], v[72:75], v[228:231], v[24:27]
    v_mfma_f32_16x16x32_bf16 v[28:31], v[72:75], v[232:235], v[28:31]
    v_mfma_f32_16x16x32_bf16 v[32:35], v[72:75], v[236:239], v[32:35]
    s_waitcnt vmcnt(0)
    v_mfma_f32_16x16x32_bf16 v[20:23], v[76:79], v[240:243], v[20:23]
    v_mfma_f32_16x16x32_bf16 v[24:27], v[76:79], v[244:247], v[24:27]
    v_mfma_f32_16x16x32_bf16 v[28:31], v[76:79], v[248:251], v[28:31]
    v_mfma_f32_16x16x32_bf16 v[32:35], v[76:79], v[252:255], v[32:35]
    s_nop 4
    ds_write_b128 v7, v[20:23] offset:4096
    ds_write_b128 v7, v[24:27] offset:5120
    ds_write_b128 v7, v[28:31] offset:6144
    ds_write_b128 v7, v[32:35] offset:7168
    s_branch Lc_ep
Lc_t1:
    s_mov_b32 s24, s50
    s_cmp_lg_u32 s7, 0
    s_cbranch_scc0 Lc_g1_0
    s_add_u32 s6, s50, 0
    buffer_load_dwordx4 v[36:39], v1, s[12:15], s6 offen offset:0 sc1
    buffer_load_dwordx4 v[40:43], v1, s[12:15], s6 offen offset:1024 sc1
    buffer_load_dwordx4 v[44:47], v1, s[12:15], s6 offen offset:2048 sc1
    buffer_load_dwordx4 v[48:51], v1, s[12:15], s6 offen offset:3072 sc1
    s_cmp_eq_u32 s7, 4
    s_cbranch_scc1 Lc_g1_4
    s_add_u32 s6, s50, 4096
    buffer_load_dwordx4 v[52:55], v1, s[12:15], s6 offen offset:0 sc1
    buffer_load_dwordx4 v[56:59], v1, s[12:15], s6 offen offset:1024 sc1
    buffer_load_dwordx4 v[60:63], v1, s[12:15], s6 offen offset:2048 sc1
    s_cmp_eq_u32 s7, 8
    s_cbranch_scc1 Lc_g1_8
Lc_g1_0:
    s_waitcnt vmcnt(10)
    v_mfma_f32_16x16x32_bf16 v[20:23], v[36:39], v[80:83], 0
    v_mfma_f32_16x16x32_bf16 v[24:27], v[36:39], v[84:87], 0
    v_mfma_f32_16x16x32_bf16 v[28:31], v[36:39], v[88:91], 0
    v_mfma_f32_16x16x32_bf16 v[32:35], v[36:39], v[92:95], 0
    s_add_u32 s6, s50, 0
    buffer_load_dwordx4 v[36:39], v1, s[12:15], s6 offen offset:0 sc1
Lc_g1_1:
    s_waitcnt vmcnt(10)
    v_mfma_f32_16x16x32_bf16 v[20:23], v[40:43], v[96:99], v[20:23]
    v_mfma_f32_16x16x32_bf16 v[24:27], v[40:43], v[100:103], v[24:27]
    v_mfma_f32_16x16x32_bf16 v[28:31], v[40:43], v[104:107], v[28:31]
    v_mfma_f32_16x16x32_bf16 v[32:35], v[40:43], v[108:111], v[32:35]
    buffer_load_dwordx4 v[40:43], v1, s[12:15], s6 offen offset:1024 sc1
Lc_g1_2:
    s_waitcnt vmcnt(10)
    v_mfma_f32_16x16x32_bf16 v[20:23], v[44:47], v[112:115], v[20:23]
    v_mfma_f32_16x16x32_bf16 v[24:27], v[44:47], v[116:119], v[24:27]
    v_mfma_f32_16x16x32_bf16 v[28:31], v[44:47], v[120:123], v[28:31]
    v_mfma_f32_16x16x32_bf16 v[32:35], v[44:47], v[124:127], v[32:35]
    buffer_load_dwordx4 v[44:47], v1, s[12:15], s6 offen offset:2048 sc1
Lc_g1_3:
    s_waitcnt vmcnt(10)
    v_mfma_f32_16x16x32_bf16 v[20:23], v[48:51], v[128:131], v[20:23]
    v_mfma_f32_16x16x32_bf16 v[24:27], v[48:51], v[132:135], v[24:27]
    v_mfma_f32_16x16x32_bf16 v[28:31], v[48:51], v[136:139], v[28:31]
    v_mfma_f32_16x16x32_bf16 v[32:35], v[48:51], v[140:143], v[32:35]
    buffer_load_dwordx4 v[48:51], v1, s[12:15], s6 offen offset:3072 sc1
Lc_g1_4:
    s_buffer_load_dwordx16 s[56:71], s[12:15], s34 glc
    s_waitcnt vmcnt(10)
    v_mfma_f32_16x16x32_bf16 v[20:23], v[52:55], v[144:147], v[20:23]
    v_mfma_f32_16x16x32_bf16 v[24:27], v[52:55], v[148:151], v[24:27]
    v_mfma_f32_16x16x32_bf16 v[28:31], v[52:55], v[152:155], v[28:31]
    v_mfma_f32_16x16x32_bf16 v[32:35], v[52:55], v[156:159], v[32:35]
    s_add_u32 s6, s50, 4096
    buffer_load_dwordx4 v[52:55], v1, s[12:15], s6 offen offset:0 sc1
Lc_g1_5:
    s_waitcnt vmcnt(10)
    v_mfma_f32_16x16x32_bf16 v[20:23], v[56:59], v[160:163], v[20:23]
    v_mfma_f32_16x16x32_bf16 v[24:27], v[56:59], v[164:167], v[24:27]
    v_mfma_f32_16x16x32_bf16 v[28:31], v[56:59], v[168:171], v[28:31]
    v_mfma_f32_16x16x32_bf16 v[32:35], v[56:59], v[172:175], v[32:35]
    buffer_load_dwordx4 v[56:59], v1, s[12:15], s6 offen offset:1024 sc1
Lc_g1_6:
    s_waitcnt vmcnt(10)
    v_mfma_f32_16x16x32_bf16 v[20:23], v[60:63], v[176:179], v[20:23]
    v_mfma_f32_16x16x32_bf16 v[24:27], v[60:63], v[180:183], v[24:27]
    v_mfma_f32_16x16x32_bf16 v[28:31], v[60:63], v[184:187], v[28:31]
    v_mfma_f32_16x16x32_bf16 v[32:35], v[60:63], v[188:191], v[32:35]
    buffer_load_dwordx4 v[60:63], v1, s[12:15], s6 offen offset:2048 sc1
Lc_g1_7:
    s_waitcnt vmcnt(10)
    v_mfma_f32_16x16x32_bf16 v[20:23], v[64:67], v[192:195], v[20:23]
    v_mfma_f32_16x16x32_bf16 v[24:27], v[64:67], v[196:199], v[24:27]
    v_mfma_f32_16x16x32_bf16 v[28:31], v[64:67], v[200:203], v[28:31]
    v_mfma_f32_16x16x32_bf16 v[32:35], v[64:67], v[204:207], v[32:35]
Lc_g1_8:
    s_waitcnt vmcnt(9)
    v_mfma_f32_16x16x32_bf16 v[20:23], v[68:71], v[208:211], v[20:23]
    v_mfma_f32_16x16x32_bf16 v[24:27], v[68:71], v[212:215], v[24:27]
    v_mfma_f32_16x16x32_bf16 v[28:31], v[68:71], v[216:219], v[28:31]
    v_mfma_f32_16x16x32_bf16 v[32:35], v[68:71], v[220:223], v[32:35]
Lc_g1_9:
    s_waitcnt vmcnt(8)
    v_mfma_f32_16x16x32_bf16 v[20:23], v[72:75], v[224:227], v[20:23]
    v_mfma_f32_16x16x32_bf16 v[24:27], v[72:75], v[228:231], v[24:27]
    v_mfma_f32_16x16x32_bf16 v[28:31], v[72:75], v[232:235], v[28:31]
    v_mfma_f32_16x16x32_bf16 v[32:35], v[72:75], v[236:239], v[32:35]
Lc_g1_10:
    s_waitcnt vmcnt(7)
    v_mfma_f32_16x16x32_bf16 v[20:23], v[76:79], v[240:243], v[20:23]
    v_mfma_f32_16x16x32_bf16 v[24:27], v[76:79], v[244:247], v[24:27]
    v_mfma_f32_16x16x32_bf16 v[28:31], v[76:79], v[248:251], v[28:31]
    v_mfma_f32_16x16x32_bf16 v[32:35], v[76:79], v[252:255], v[32:35]
    s_nop 4
    ds_write_b128 v7, v[20:23] offset:4096
    ds_write_b128 v7, v[24:27] offset:5120
    ds_write_b128 v7, v[28:31] offset:6144
    ds_write_b128 v7, v[32:35] offset:7168
Lc_ep:
    s_add_u32 s51, s51, 0x100000
    s_add_u32 s52, s52, 4096
    s_mov_b32 s7, 0
    ds_write_b32 v1, v1 offset:36352
    ds_write_b32 v1, v1 offset:36352
    s_waitcnt lgkmcnt(2)
    v_xor_b32 v35, 128, v13
    s_barrier
    ds_read_b128 v[64:67], v13 offset:0
    ds_read_b128 v[68:71], v35 offset:0
    ds_read_b128 v[72:75], v13 offset:8192
    ds_read_b128 v[76:79], v35 offset:8192
    ds_read_b128 v[20:23], v13 offset:16384
    ds_read_b128 v[24:27], v35 offset:16384
    ds_read_b128 v[28:31], v13 offset:24576
    ds_read_b128 v[32:35], v35 offset:24576
    ds_write_b32 v1, v1 offset:36352
    ds_write_b32 v1, v1 offset:36352
    s_cmp_lg_u32 s24, s55
    s_cbranch_scc1 Lc_l2
    s_cmp_eq_u32 s49, 4
    s_cbranch_scc1 Lc_l3
    s_and_b64 s[4:5], s[56:57], s[58:59]
    s_and_b64 s[4:5], s[4:5], s[60:61]
    s_and_b64 s[4:5], s[4:5], s[62:63]
    s_and_b64 s[4:5], s[4:5], s[64:65]
    s_and_b64 s[4:5], s[4:5], s[66:67]
    s_and_b64 s[4:5], s[4:5], s[68:69]
    s_and_b64 s[4:5], s[4:5], s[70:71]
    s_and_b32 s4, s4, s5
    s_bitcmp0_b32 s4, s49
    s_cbranch_scc1 Lc_l2
    s_mov_b32 s24, s50
    s_add_u32 s6, s50, 0
    buffer_load_dwordx4 v[36:39], v1, s[12:15], s6 offen offset:0 sc1
    buffer_load_dwordx4 v[40:43], v1, s[12:15], s6 offen offset:1024 sc1
    buffer_load_dwordx4 v[44:47], v1, s[12:15], s6 offen offset:2048 sc1
    buffer_load_dwordx4 v[48:51], v1, s[12:15], s6 offen offset:3072 sc1
    s_add_u32 s6, s50, 4096
    buffer_load_dwordx4 v[52:55], v1, s[12:15], s6 offen offset:0 sc1
    buffer_load_dwordx4 v[56:59], v1, s[12:15], s6 offen offset:1024 sc1
    buffer_load_dwordx4 v[60:63], v1, s[12:15], s6 offen offset:2048 sc1
    s_branch Lc_l2
Lc_l3:
    s_cmp_eq_u64 s[28:29], -1
    s_cbranch_scc1 Lc_ea0
Lc_eb0:
    s_buffer_load_dwordx2 s[28:29], s[12:15], s35 glc
Lc_l2:
    s_waitcnt lgkmcnt(6)
    v_pk_add_f32 v[64:65], v[64:65], v[72:73]
    v_pk_add_f32 v[66:67], v[66:67], v[74:75]
    v_pk_add_f32 v[68:69], v[68:69], v[76:77]
    v_pk_add_f32 v[70:71], v[70:71], v[78:79]
    v_lshlrev_b32 v72, 16, v16
    v_and_b32 v73, s44, v16
    v_lshlrev_b32 v74, 16, v17
    v_and_b32 v75, s44, v17
    v_lshlrev_b32 v76, 16, v18
    v_and_b32 v77, s44, v18
    v_lshlrev_b32 v78, 16, v19
    v_and_b32 v79, s44, v19
    v_pk_fma_f32 v[72:73], v[64:65], v[8:9], v[72:73]
    v_pk_fma_f32 v[74:75], v[66:67], v[10:11], v[74:75]
    v_pk_fma_f32 v[76:77], v[68:69], v[8:9], v[76:77]
    v_pk_fma_f32 v[78:79], v[70:71], v[10:11], v[78:79]
    s_waitcnt lgkmcnt(4)
    v_pk_fma_f32 v[72:73], v[20:21], v[8:9], v[72:73]
    v_pk_fma_f32 v[74:75], v[22:23], v[10:11], v[74:75]
    v_pk_fma_f32 v[76:77], v[24:25], v[8:9], v[76:77]
    v_pk_fma_f32 v[78:79], v[26:27], v[10:11], v[78:79]
    s_waitcnt lgkmcnt(2)
    v_pk_fma_f32 v[20:21], v[28:29], v[8:9], v[72:73]
    v_pk_fma_f32 v[22:23], v[30:31], v[10:11], v[74:75]
    v_pk_fma_f32 v[24:25], v[32:33], v[8:9], v[76:77]
    v_pk_fma_f32 v[26:27], v[34:35], v[10:11], v[78:79]
    s_cmp_lg_u32 s16, 0
    v_cvt_pk_bf16_f32 v28, v20, v24
    v_cvt_pk_bf16_f32 v29, v21, v25
    v_cvt_pk_bf16_f32 v30, v22, v26
    v_cvt_pk_bf16_f32 v31, v23, v27
    s_cbranch_scc1 Lc_out
    s_cmp_eq_u64 s[28:29], -1
    s_cbranch_scc1 Lc_ea1
Lc_eb1:
    buffer_store_dwordx4 v[28:31], v15, s[12:15], s53 offen sc0 sc1
    v_pk_mul_f32 v[16:17], v[20:21], v[20:21]
    v_pk_mul_f32 v[18:19], v[22:23], v[22:23]
    v_pk_add_f32 v[20:21], v[20:21], v[24:25]
    v_pk_add_f32 v[22:23], v[22:23], v[26:27]
    v_pk_fma_f32 v[24:25], v[24:25], v[24:25], v[16:17]
    v_pk_fma_f32 v[26:27], v[26:27], v[26:27], v[18:19]
    v_lshl_add_u32 v33, s3, 2, v1
    v_permlane32_swap_b32 v20, v24
    v_permlane32_swap_b32 v21, v25
    v_permlane32_swap_b32 v22, v26
    v_permlane32_swap_b32 v23, v27
    v_add_f32 v20, v20, v24
    v_add_f32 v21, v21, v25
    v_add_f32 v22, v22, v26
    v_add_f32 v23, v23, v27
    v_permlane16_swap_b32 v20, v21
    s_nop 0
    v_permlane16_swap_b32 v22, v23
    v_add_f32 v20, v20, v21
    v_add_f32 v22, v22, v23
    s_nop 0
    v_add_f32_dpp v20, v20, v20 row_ror:8 row_mask:0xf bank_mask:0x3
    s_nop 1
    v_add_f32_dpp v20, v22, v22 row_ror:8 row_mask:0xf bank_mask:0xc
    ds_write_b32 v33, v20 offset:35328
    ds_write_b32 v1, v1 offset:36352
    ds_write_b32 v1, v1 offset:36352
    v_lshrrev_b32 v32, 9, v1
    v_lshl_add_u32 v32, v32, 13, v0
    v_bfe_u32 v33, v1, 7, 1
    v_lshl_add_u32 v32, v33, 3, v32
    s_add_u32 s53, s53, 4096
    s_cmp_eq_u32 s3, 3
    s_cselect_b32 s26, s54, s55
    s_waitcnt lgkmcnt(2)
    s_barrier
    ds_read_b128 v[20:23], v1 offset:35328
    ds_write_b32 v1, v1 offset:36352
    ds_write_b32 v1, v1 offset:36352
    v_bfe_u32 v33, v1, 8, 1
    v_lshl_add_u32 v32, v33, 2, v32
    s_cmp_eq_u64 s[28:29], -1
    s_cbranch_scc1 Lc_ea2
Lc_eb2:
    s_cmp_eq_u32 s49, 4
    s_waitcnt lgkmcnt(2)
    s_buffer_load_dwordx2 s[28:29], s[12:15], s35 glc
    s_buffer_load_dwordx16 s[56:71], s[12:15], s34 glc
    v_add_f32 v20, v20, v21
    v_add_f32 v22, v22, v23
    v_add_f32 v20, v20, v22
    buffer_atomic_add_f32 v20, v32, s[12:15], s26 offen
    s_cbranch_scc1 Lc_next
    s_add_u32 s54, s54, 4096
    s_mov_b32 s27, 1
    s_cmp_eq_u32 s24, s55
    s_cbranch_scc1 Lc_l4
    buffer_load_dwordx4 v[64:67], v1, s[12:15], s6 offen offset:3072 sc1
    s_add_u32 s6, s50, 8192
    buffer_load_dwordx4 v[68:71], v1, s[12:15], s6 offen offset:0 sc1
    buffer_load_dwordx4 v[72:75], v1, s[12:15], s6 offen offset:1024 sc1
    buffer_load_dwordx4 v[76:79], v1, s[12:15], s6 offen offset:2048 sc1
    buffer_load_dword v16, off, s[12:15], s55
    buffer_load_dword v16, off, s[12:15], s55
    buffer_load_dword v16, off, s[12:15], s55
    buffer_load_dword v16, off, s[12:15], s55
Lc_l4:
Lc_l5:
    s_cmp_eq_u32 s24, s55
    s_cbranch_scc1 Lc_dloop
    s_and_b64 s[4:5], s[56:57], s[58:59]
    s_and_b64 s[4:5], s[4:5], s[60:61]
    s_and_b64 s[4:5], s[4:5], s[62:63]
    s_and_b64 s[4:5], s[4:5], s[64:65]
    s_and_b64 s[4:5], s[4:5], s[66:67]
    s_and_b64 s[4:5], s[4:5], s[68:69]
    s_and_b64 s[4:5], s[4:5], s[70:71]
    s_and_b32 s4, s4, s5
    s_branch Lc_s0
Lc_next:
    s_setprio 3
    s_add_u32 s48, s48, 557056
    s_cmp_lg_u32 s7, 0
    s_cbranch_scc1 Lc_early
    s_waitcnt lgkmcnt(0)
    s_cmp_lg_u64 s[28:29], -1
    s_cbranch_scc1 Lc_late
    buffer_load_dwordx4 v[36:39], v4, s[12:15], s20 offen sc1
    buffer_load_dwordx4 v[40:43], v4, s[12:15], s21 offen sc1
    buffer_load_dwordx4 v[44:47], v4, s[12:15], s19 offen sc1
    buffer_load_dword v16, off, s[12:15], s55
    s_waitcnt vmcnt(4)
    s_mov_b64 exec, 1
    v_mov_b32 v12, -1
    buffer_store_byte v12, off, s[12:15], s48
    s_mov_b64 exec, -1
    s_branch Lc_early
Lc_late:
    s_buffer_load_dwordx2 s[56:57], s[12:15], s33 glc
    s_waitcnt vmcnt(0)
    s_mov_b64 exec, 1
    v_mov_b32 v12, -1
    buffer_store_byte v12, off, s[12:15], s48
    s_mov_b64 exec, -1
    s_waitcnt lgkmcnt(0)
    s_cmp_eq_u64 s[56:57], -1
    s_cbranch_scc1 Lc_pax
    s_branch Lc_pae
Lc_pa:
    s_and_b32 s26, s9, 63
    s_cbranch_scc1 Lc_paf
    s_mov_b64 exec, 1
    v_mov_b32 v12, 2
    buffer_atomic_umax v12, off, s[12:15], s32
    s_mov_b64 exec, -1
Lc_paf:
    s_sleep 2
Lc_pae:
    s_buffer_load_dwordx2 s[56:57], s[12:15], s33 glc
    s_sub_u32 s9, s9, 1
    s_cmp_lt_i32 s9, 0
    s_waitcnt lgkmcnt(0)
    s_cbranch_scc1 Lc_pax
    s_cmp_lg_u64 s[56:57], -1
    s_cbranch_scc1 Lc_pa
Lc_pax:
    buffer_load_dwordx4 v[36:39], v4, s[12:15], s20 offen sc1
    buffer_load_dwordx4 v[40:43], v4, s[12:15], s21 offen sc1
    buffer_load_dwordx4 v[44:47], v4, s[12:15], s19 offen sc1
    buffer_load_dword v16, off, s[12:15], s55
    buffer_load_dword v16, off, s[12:15], s55
Lc_early:
    s_waitcnt vmcnt(4)
    v_mov_b32 v76, 0x3727c5ac
    v_pk_mul_f32 v[36:37], v[36:37], s[40:41]
    v_pk_mul_f32 v[38:39], v[38:39], s[40:41]
    v_pk_fma_f32 v[68:69], v[36:37], v[36:37], v[76:77] op_sel_hi:[1,1,0] neg_lo:[1,0,0] neg_hi:[1,0,0]
    v_pk_fma_f32 v[70:71], v[38:39], v[38:39], v[76:77] op_sel_hi:[1,1,0] neg_lo:[1,0,0] neg_hi:[1,0,0]
    s_waitcnt vmcnt(3)
    v_pk_fma_f32 v[40:41], v[40:41], s[40:41], v[68:69]
    v_pk_fma_f32 v[42:43], v[42:43], s[40:41], v[70:71]
    v_rsq_f32 v40, |v40|
    v_rsq_f32 v41, |v41|
    v_rsq_f32 v42, |v42|
    v_rsq_f32 v43, |v43|
    v_lshrrev_b32 v76, 1, v4
    s_waitcnt vmcnt(2)
    v_lshlrev_b32 v68, 16, v44
    v_lshlrev_b32 v69, 16, v45
    v_lshlrev_b32 v70, 16, v46
    v_lshlrev_b32 v71, 16, v47
    v_pk_mul_f32 v[36:37], v[36:37], v[40:41] neg_lo:[1,0] neg_hi:[1,0]
    v_pk_mul_f32 v[38:39], v[38:39], v[42:43] neg_lo:[1,0] neg_hi:[1,0]
    v_and_b32 v72, s44, v44
    v_and_b32 v73, s44, v45
    v_and_b32 v74, s44, v46
    v_and_b32 v75, s44, v47
    v_pk_fma_f32 v[68:69], v[68:69], v[40:41], v[36:37]
    v_pk_fma_f32 v[70:71], v[70:71], v[42:43], v[38:39]
    v_cvt_pk_bf16_f32 v68, v68, v69
    v_cvt_pk_bf16_f32 v69, v70, v71
    ds_write_b64 v76, v[68:69] offset:33280
    v_pk_fma_f32 v[72:73], v[72:73], v[40:41], v[36:37]
    v_pk_fma_f32 v[74:75], v[74:75], v[42:43], v[38:39]
    v_cvt_pk_bf16_f32 v72, v72, v73
    v_cvt_pk_bf16_f32 v73, v74, v75
    ds_write_b64 v76, v[72:73] offset:37888
    v_mov_b32 v8, v44
    v_mov_b32 v9, v45
    v_mov_b32 v10, v46
    v_mov_b32 v11, v47
    s_add_u32 s33, s33, 8
    s_mov_b32 s16, 4
    s_cmp_eq_u32 s7, 0
    s_cbranch_scc1 Lc_dab
    s_waitcnt vmcnt(0)
    s_mov_b64 exec, 1
    v_mov_b32 v12, -1
    buffer_store_byte v12, off, s[12:15], s48
    s_mov_b64 exec, -1
Lc_dab:
    s_waitcnt lgkmcnt(0)
    s_barrier
    s_branch Lc_layer
Lc_pc12:
    buffer_load_dwordx4 v[16:19], v4, s[12:15], s23 offen sc1
    buffer_load_dwordx4 v[12:15], v4, s[12:15], s25 offen sc1
    buffer_load_dwordx4 v[8:11], v4, s[12:15], s22 offen sc1
    s_mov_b32 s58, 1
    s_mov_b32 s47, s55
    s_lshl_b32 s27, s27, 2
    s_branch Lc_pd12
Lc_pc17:
    buffer_load_dwordx4 v[16:19], v4, s[12:15], s23 offen sc1
    buffer_load_dwordx4 v[12:15], v4, s[12:15], s25 offen sc1
    buffer_load_dwordx4 v[8:11], v4, s[12:15], s22 offen sc1
    s_mov_b32 s58, 1
    s_mov_b32 s47, s55
    s_lshl_b32 s27, s27, 2
    s_branch Lc_pd17
Lc_pc22:
    buffer_load_dwordx4 v[16:19], v4, s[12:15], s23 offen sc1
    buffer_load_dwordx4 v[12:15], v4, s[12:15], s25 offen sc1
    buffer_load_dwordx4 v[8:11], v4, s[12:15], s22 offen sc1
    s_mov_b32 s58, 1
    s_mov_b32 s47, s55
    s_lshl_b32 s27, s27, 2
    s_branch Lc_pd22
Lc_pc27:
    buffer_load_dwordx4 v[16:19], v4, s[12:15], s23 offen sc1
    buffer_load_dwordx4 v[12:15], v4, s[12:15], s25 offen sc1
    buffer_load_dwordx4 v[8:11], v4, s[12:15], s22 offen sc1
    s_mov_b32 s58, 1
    s_mov_b32 s47, s55
    s_lshl_b32 s27, s27, 2
    s_branch Lc_pd27
Lc_pc32:
    buffer_load_dwordx4 v[16:19], v4, s[12:15], s23 offen sc1
    buffer_load_dwordx4 v[12:15], v4, s[12:15], s25 offen sc1
    buffer_load_dwordx4 v[8:11], v4, s[12:15], s22 offen sc1
    s_mov_b32 s58, 1
    s_mov_b32 s47, s55
    s_lshl_b32 s27, s27, 2
    s_branch Lc_pd32
Lc_pc37:
    buffer_load_dwordx4 v[16:19], v4, s[12:15], s23 offen sc1
    buffer_load_dwordx4 v[12:15], v4, s[12:15], s25 offen sc1
    buffer_load_dwordx4 v[8:11], v4, s[12:15], s22 offen sc1
    s_mov_b32 s58, 1
    s_mov_b32 s47, s55
    s_lshl_b32 s27, s27, 2
    s_branch Lc_pd37
Lc_pc42:
    buffer_load_dwordx4 v[16:19], v4, s[12:15], s23 offen sc1
    buffer_load_dwordx4 v[12:15], v4, s[12:15], s25 offen sc1
    buffer_load_dwordx4 v[8:11], v4, s[12:15], s22 offen sc1
    s_mov_b32 s58, 1
    s_mov_b32 s47, s55
    s_lshl_b32 s27, s27, 2
    s_branch Lc_pd42
Lc_pc47:
    buffer_load_dwordx4 v[16:19], v4, s[12:15], s23 offen sc1
    buffer_load_dwordx4 v[12:15], v4, s[12:15], s25 offen sc1
    buffer_load_dwordx4 v[8:11], v4, s[12:15], s22 offen sc1
    s_mov_b32 s58, 1
    s_mov_b32 s47, s55
    s_lshl_b32 s27, s27, 2
    s_branch Lc_pd47
Lc_pc52:
    buffer_load_dwordx4 v[16:19], v4, s[12:15], s23 offen sc1
    buffer_load_dwordx4 v[12:15], v4, s[12:15], s25 offen sc1
    buffer_load_dwordx4 v[8:11], v4, s[12:15], s22 offen sc1
    s_mov_b32 s58, 1
    s_mov_b32 s47, s55
    s_lshl_b32 s27, s27, 2
    s_branch Lc_pd52
Lc_pc57:
    buffer_load_dwordx4 v[16:19], v4, s[12:15], s23 offen sc1
    buffer_load_dwordx4 v[12:15], v4, s[12:15], s25 offen sc1
    buffer_load_dwordx4 v[8:11], v4, s[12:15], s22 offen sc1
    s_mov_b32 s58, 1
    s_mov_b32 s47, s55
    s_lshl_b32 s27, s27, 2
    s_branch Lc_pd57
Lc_pc62:
    buffer_load_dwordx4 v[16:19], v4, s[12:15], s23 offen sc1
    buffer_load_dwordx4 v[12:15], v4, s[12:15], s25 offen sc1
    buffer_load_dwordx4 v[8:11], v4, s[12:15], s22 offen sc1
    s_mov_b32 s58, 1
    s_mov_b32 s47, s55
    s_lshl_b32 s27, s27, 2
    s_branch Lc_pd62
Lc_fa0:
    v_mov_b32 v28, -1
    v_mov_b32 v29, -1
    v_mov_b32 v30, -1
    v_mov_b32 v31, -1
    s_add_u32 s26, s18, 0
    buffer_store_dwordx4 v[28:31], v6, s[12:15], s26 offen sc0 sc1
    s_add_u32 s26, s18, 1048576
    buffer_store_dwordx4 v[28:31], v6, s[12:15], s26 offen sc0 sc1
    s_branch Lc_fb0
Lc_fa1:
    v_mov_b32 v28, -1
    v_mov_b32 v29, -1
    v_mov_b32 v30, -1
    v_mov_b32 v31, -1
    s_add_u32 s26, s18, 0
    buffer_store_dwordx4 v[28:31], v6, s[12:15], s26 offen sc0 sc1
    s_add_u32 s26, s18, 1048576
    buffer_store_dwordx4 v[28:31], v6, s[12:15], s26 offen sc0 sc1
    s_waitcnt vmcnt(0)
    s_branch Lc_fb1
Lc_ea0:
    s_cmp_lg_u32 s7, 0
    s_cbranch_scc1 Lc_eb0
    buffer_load_dwordx4 v[36:39], v4, s[12:15], s20 offen sc1
    buffer_load_dwordx4 v[40:43], v4, s[12:15], s21 offen sc1
    buffer_load_dwordx4 v[44:47], v4, s[12:15], s19 offen sc1
    s_mov_b32 s7, -1
    s_mov_b32 s35, s55
    s_branch Lc_eb0
Lc_ea1:
    s_cmp_lg_u32 s7, 0
    s_cbranch_scc1 Lc_eb1
    buffer_load_dwordx4 v[36:39], v4, s[12:15], s20 offen sc1
    buffer_load_dwordx4 v[40:43], v4, s[12:15], s21 offen sc1
    buffer_load_dwordx4 v[44:47], v4, s[12:15], s19 offen sc1
    s_mov_b32 s7, -1
    s_mov_b32 s35, s55
    s_branch Lc_eb1
Lc_ea2:
    s_cmp_lg_u32 s7, 0
    s_cbranch_scc1 Lc_eb2
    buffer_load_dwordx4 v[36:39], v4, s[12:15], s20 offen sc1
    buffer_load_dwordx4 v[40:43], v4, s[12:15], s21 offen sc1
    buffer_load_dwordx4 v[44:47], v4, s[12:15], s19 offen sc1
    buffer_load_dword v16, off, s[12:15], s55
    s_mov_b32 s7, -1
    s_mov_b32 s35, s55
    s_branch Lc_eb2
Lc_out:
    s_cmp_eq_u32 s49, 8
    s_cbranch_scc1 Lc_o4
    s_buffer_load_dwordx16 s[56:71], s[12:15], s34 glc
    s_cmp_lg_u32 s3, 0
    s_cbranch_scc1 Lc_o3
    s_mov_b64 exec, 1
    v_mov_b32 v12, 5
    buffer_atomic_umax v12, off, s[12:15], s32
    s_mov_b64 exec, -1
Lc_o3:
    s_cmp_eq_u32 s24, s55
    s_cbranch_scc1 Lc_o4
    buffer_load_dwordx4 v[64:67], v1, s[12:15], s6 offen offset:3072 sc1
    s_add_u32 s6, s50, 8192
    buffer_load_dwordx4 v[68:71], v1, s[12:15], s6 offen offset:0 sc1
    buffer_load_dwordx4 v[72:75], v1, s[12:15], s6 offen offset:1024 sc1
    buffer_load_dwordx4 v[76:79], v1, s[12:15], s6 offen offset:2048 sc1
Lc_o4:
    buffer_store_dword v28, v15, s[36:39], s53 offen offset:0
    buffer_store_dword v29, v15, s[36:39], s53 offen offset:1024
    buffer_store_dword v30, v15, s[36:39], s53 offen offset:2048
    buffer_store_dword v31, v15, s[36:39], s53 offen offset:3072
    s_add_u32 s53, s53, 1048576
    s_cmp_eq_u32 s49, 8
    s_cbranch_scc1 Lc_fin
    s_barrier
    s_branch Lc_l5
Lc_fin:
    s_endpgm
Lu_role:
    s_setprio 1
    s_sub_u32 s17, s2, 256
    s_and_b32 s6, s17, 7
    s_lshr_b32 s7, s17, 3
    s_and_b32 s30, s7, 7
    s_and_b32 s26, s6, 4
    s_lshl1_add_u32 s30, s26, s30
    s_lshr_b32 s31, s7, 3
    s_and_b32 s26, s6, 3
    s_bfe_u32 s27, s7, 0x20001
    s_cmp_ge_u32 s7, 24
    s_cselect_b32 s27, s27, 3
    s_cmp_gt_u32 s26, s27
    s_subb_u32 s28, s26, 0
    s_cmp_eq_u32 s26, s27
    s_cselect_b32 s26, 3, s28
    s_lshl2_add_u32 s31, s26, s31
    s_mul_i32 s46, s3, 64
    s_add_u32 s46, s46, s17
    s_and_b32 s46, s46, 255
    s_mul_i32 s46, s46, 4352
    s_add_u32 s46, s46, 722176
    s_mul_i32 s48, s30, 69632
    s_lshl2_add_u32 s48, s31, s48
    s_add_u32 s48, s48, 721152
    s_cmp_eq_u32 s3, 1
    s_cselect_b32 s48, s48, s55
    s_mov_b32 s8, 1
    v_mul_u32_u24 v6, 272, v1
    s_lshl_b32 s18, s30, 16
    s_add_u32 s18, s18, 8454144
    s_lshl_b32 s23, s3, 11
    s_add_u32 s18, s18, s23
    v_and_b32 v2, 256, v1
    v_lshrrev_b32 v2, 3, v2
    v_xor_b32 v7, v1, v2
    v_and_b32 v3, 0x3c0, v1
    v_add_u32 v2, v2, v3
    v_bfe_u32 v3, v1, 4, 2
    v_lshl_add_u32 v2, v3, 3, v2
    v_mov_b32 v61, 0
    s_mov_b32 s47, 200
    s_mov_b32 s45, s47
    s_lshl2_add_u32 s26, s7, s3
    s_mul_i32 s29, s26, 11264
    s_add_u32 s29, s29, 24444928
    s_mul_i32 s26, s26, 6144
    s_and_b32 s27, s6, 3
    s_mul_i32 s27, s27, 786432
    s_add_u32 s26, s26, s27
    s_add_u32 s26, s26, 26017792
    v_lshlrev_b32 v8, 3, v1
    s_waitcnt lgkmcnt(0)
    s_mov_b32 s12, s4
    s_and_b32 s13, s5, 0xffff
    s_cmp_eq_u32 s31, 15
    s_cbranch_scc1 Ls_role
    s_lshl2_add_u32 s24, s31, s3
    s_mul_i32 s35, s24, 49152
    s_add_u32 s35, s35, 26017792
    s_add_u32 s37, s35, 32768
    s_bitcmp1_b32 s3, 0
    s_cselect_b32 s37, s35, s37
    s_cselect_b32 s36, 16384, 0
    s_add_u32 s35, s35, s36
    s_add_u32 s36, s35, 16384
    s_mul_i32 s19, s30, 184320
    s_mul_i32 s26, s24, 768
    s_add_u32 s19, s19, s26
    s_add_u32 s19, s19, 12648448
    v_xor_b32 v3, 32, v2
    v_mov_b32 v4, 1073741824
    v_cmp_gt_u32 vcc, 768, v1
    s_nop 1
    v_cndmask_b32 v4, v4, v1, vcc
    s_sleep 8
    buffer_load_dwordx4 v[64:67], v1, s[12:15], s35 offen offset:0
    buffer_load_dwordx4 v[68:71], v1, s[12:15], s36 offen offset:0
    buffer_load_dwordx4 v[72:75], v1, s[12:15], s37 offen offset:0
    buffer_load_dwordx4 v[76:79], v1, s[12:15], s35 offen offset:1024
    buffer_load_dwordx4 v[80:83], v1, s[12:15], s36 offen offset:1024
    buffer_load_dwordx4 v[84:87], v1, s[12:15], s37 offen offset:1024
    buffer_load_dwordx4 v[88:91], v1, s[12:15], s35 offen offset:2048
    buffer_load_dwordx4 v[92:95], v1, s[12:15], s36 offen offset:2048
    buffer_load_dwordx4 v[96:99], v1, s[12:15], s37 offen offset:2048
    buffer_load_dwordx4 v[100:103], v1, s[12:15], s35 offen offset:3072
    s_add_u32 s35, s35, 4096
    buffer_load_dwordx4 v[104:107], v1, s[12:15], s36 offen offset:3072
    s_add_u32 s36, s36, 4096
    buffer_load_dwordx4 v[108:111], v1, s[12:15], s37 offen offset:3072
    s_add_u32 s37, s37, 4096
    buffer_load_dwordx4 v[112:115], v1, s[12:15], s35 offen offset:0
    buffer_load_dwordx4 v[116:119], v1, s[12:15], s36 offen offset:0
    buffer_load_dwordx4 v[120:123], v1, s[12:15], s37 offen offset:0
    buffer_load_dwordx4 v[124:127], v1, s[12:15], s35 offen offset:1024
    s_waitcnt vmcnt(14)
    buffer_load_dwordx4 v[128:131], v1, s[12:15], s36 offen offset:1024
    buffer_load_dwordx4 v[132:135], v1, s[12:15], s37 offen offset:1024
    s_waitcnt vmcnt(14)
    buffer_load_dwordx4 v[136:139], v1, s[12:15], s35 offen offset:2048
    buffer_load_dwordx4 v[140:143], v1, s[12:15], s36 offen offset:2048
    s_waitcnt vmcnt(14)
    buffer_load_dwordx4 v[144:147], v1, s[12:15], s37 offen offset:2048
    buffer_load_dwordx4 v[148:151], v1, s[12:15], s35 offen offset:3072
    s_add_u32 s35, s35, 4096
    s_waitcnt vmcnt(14)
    buffer_load_dwordx4 v[152:155], v1, s[12:15], s36 offen offset:3072
    s_add_u32 s36, s36, 4096
    buffer_load_dwordx4 v[156:159], v1, s[12:15], s37 offen offset:3072
    s_add_u32 s37, s37, 4096
    s_waitcnt vmcnt(14)
    buffer_load_dwordx4 v[160:163], v1, s[12:15], s35 offen offset:0
    buffer_load_dwordx4 v[164:167], v1, s[12:15], s36 offen offset:0
    s_waitcnt vmcnt(14)
    buffer_load_dwordx4 v[168:171], v1, s[12:15], s37 offen offset:0
    buffer_load_dwordx4 v[172:175], v1, s[12:15], s35 offen offset:1024
    s_waitcnt vmcnt(14)
    buffer_load_dwordx4 v[176:179], v1, s[12:15], s36 offen offset:1024
    buffer_load_dwordx4 v[180:183], v1, s[12:15], s37 offen offset:1024
    s_waitcnt vmcnt(14)
    buffer_load_dwordx4 v[184:187], v1, s[12:15], s35 offen offset:2048
    buffer_load_dwordx4 v[188:191], v1, s[12:15], s36 offen offset:2048
    s_waitcnt vmcnt(14)
    buffer_load_dwordx4 v[192:195], v1, s[12:15], s37 offen offset:2048
    buffer_load_dwordx4 v[196:199], v1, s[12:15], s35 offen offset:3072
    s_add_u32 s35, s35, 4096
    s_waitcnt vmcnt(14)
    buffer_load_dwordx4 v[200:203], v1, s[12:15], s36 offen offset:3072
    s_add_u32 s36, s36, 4096
    buffer_load_dwordx4 v[204:207], v1, s[12:15], s37 offen offset:3072
    s_add_u32 s37, s37, 4096
    s_waitcnt vmcnt(14)
    buffer_load_dwordx4 v[208:211], v1, s[12:15], s35 offen offset:0
    buffer_load_dwordx4 v[212:215], v1, s[12:15], s36 offen offset:0
    s_waitcnt vmcnt(14)
    buffer_load_dwordx4 v[216:219], v1, s[12:15], s37 offen offset:0
    buffer_load_dwordx4 v[220:223], v1, s[12:15], s35 offen offset:1024
    s_waitcnt vmcnt(14)
    buffer_load_dwordx4 v[224:227], v1, s[12:15], s36 offen offset:1024
    buffer_load_dwordx4 v[228:231], v1, s[12:15], s37 offen offset:1024
    s_waitcnt vmcnt(14)
    buffer_load_dwordx4 v[232:235], v1, s[12:15], s35 offen offset:2048
    buffer_load_dwordx4 v[236:239], v1, s[12:15], s36 offen offset:2048
    s_waitcnt vmcnt(14)
    buffer_load_dwordx4 v[240:243], v1, s[12:15], s37 offen offset:2048
    buffer_load_dwordx4 v[244:247], v1, s[12:15], s35 offen offset:3072
    s_waitcnt vmcnt(14)
    buffer_load_dwordx4 v[248:251], v1, s[12:15], s36 offen offset:3072
    buffer_load_dwordx4 v[252:255], v1, s[12:15], s37 offen offset:3072
Lu_chunk:
    s_mov_b64 s[42:43], s[18:19]
    s_mov_b32 s44, s46
    s_mov_b32 s45, s8
    v_mov_b32 v62, v61
Lu_again:
    v_mov_b32 v8, 0
    v_mov_b32 v12, 0
    v_mov_b32 v20, 0
    v_mov_b32 v24, 0
    s_cmp_lg_u32 s3, 0
    s_cbranch_scc1 Lu_wb
Lu_ws:
Lu_wse:
    s_buffer_load_dwordx2 s[56:57], s[12:15], s46 glc
    s_sub_u32 s9, s9, 1
    s_cmp_lt_i32 s9, 0
    s_waitcnt lgkmcnt(0)
    s_cbranch_scc1 Lu_wsx
    s_cmp_lg_u64 s[56:57], -1
    s_cbranch_scc1 Lu_ws
Lu_wsx:
Lu_wb:
    s_barrier
    s_mov_b32 m0, s23
    s_mov_b32 s27, s18
    buffer_load_dwordx4 v7, s[12:15], s27 offen sc1 lds
    buffer_load_dwordx4 v7, s[12:15], s27 offen offset:1024 sc1 lds
    s_add_u32 m0, m0, 8192
    s_add_u32 s27, s27, 8192
    buffer_load_dwordx4 v7, s[12:15], s27 offen sc1 lds
    buffer_load_dwordx4 v7, s[12:15], s27 offen offset:1024 sc1 lds
    s_add_u32 m0, m0, 8192
    s_add_u32 s27, s27, 8192
    buffer_load_dwordx4 v7, s[12:15], s27 offen sc1 lds
    buffer_load_dwordx4 v7, s[12:15], s27 offen offset:1024 sc1 lds
    s_add_u32 m0, m0, 8192
    s_add_u32 s27, s27, 8192
    buffer_load_dwordx4 v7, s[12:15], s27 offen sc1 lds
    buffer_load_dwordx4 v7, s[12:15], s27 offen offset:1024 sc1 lds
    s_add_u32 m0, m0, 8192
    s_add_u32 s27, s27, 8192
    s_mov_b32 s21, s55
    s_mov_b32 s33, s55
    s_mov_b32 s22, s55
    s_add_u32 s25, s23, 32768
    s_waitcnt vmcnt(6)
    s_barrier
    ds_read_b64_tr_b16 v[32:33], v2 offset:0
    ds_read_b64_tr_b16 v[34:35], v2 offset:1024
    ds_read_b64_tr_b16 v[36:37], v3 offset:0
    ds_read_b64_tr_b16 v[38:39], v3 offset:1024
    ds_read_b64_tr_b16 v[40:41], v2 offset:2048
    ds_read_b64_tr_b16 v[42:43], v2 offset:3072
Lu_even:
    s_add_u32 s46, s46, 8
    s_add_u32 s18, s18, 0x100000
    s_waitcnt lgkmcnt(4)
    v_mul_f32 v48, v8, v12
    v_mul_f32 v49, v9, v13
    v_mul_f32 v50, v10, v14
    v_mul_f32 v51, v11, v15
    v_mfma_f32_16x16x32_bf16 v[8:11], v[64:67], v[32:35], 0
    s_add_u32 s20, s21, 92160
    ds_read_b64_tr_b16 v[44:45], v3 offset:2048
    v_mfma_f32_16x16x32_bf16 v[12:15], v[68:71], v[32:35], 0
    ds_read_b64_tr_b16 v[46:47], v3 offset:3072
    v_mul_f32 v52, v16, v18
    v_mul_f32 v53, v17, v19
    v_mfma_f32_16x16x32_bf16 v[16:19], v[72:75], v[32:35], 0
    s_waitcnt lgkmcnt(4)
    v_mul_f32 v54, v20, v24
    v_mul_f32 v55, v21, v25
    v_mul_f32 v56, v22, v26
    v_mul_f32 v57, v23, v27
    v_mfma_f32_16x16x32_bf16 v[20:23], v[64:67], v[36:39], 0
    ds_read_b64_tr_b16 v[32:33], v2 offset:4096
    v_cmp_u_f32 vcc, v48, v54
    v_mfma_f32_16x16x32_bf16 v[24:27], v[68:71], v[36:39], 0
    ds_read_b64_tr_b16 v[34:35], v2 offset:5120
    v_mul_f32 v58, v28, v30
    v_mul_f32 v59, v29, v31
    s_cbranch_vccnz Lu_rd0
Lu_bk0:
    v_mfma_f32_16x16x32_bf16 v[28:31], v[72:75], v[36:39], 0
    s_waitcnt lgkmcnt(4)
    v_mfma_f32_16x16x32_bf16 v[8:11], v[76:79], v[40:43], v[8:11]
    ds_read_b64_tr_b16 v[36:37], v3 offset:4096
    v_cvt_pk_bf16_f32 v48, v48, v49
    v_cvt_pk_bf16_f32 v49, v50, v51
    v_mfma_f32_16x16x32_bf16 v[12:15], v[80:83], v[40:43], v[12:15]
    ds_read_b64_tr_b16 v[38:39], v3 offset:5120
    v_cvt_pk_bf16_f32 v50, v52, v53
    v_cvt_pk_bf16_f32 v54, v54, v55
    v_mfma_f32_16x16x32_bf16 v[16:19], v[84:87], v[40:43], v[16:19]
    v_permlane16_swap_b32 v50, v51
    v_cvt_pk_bf16_f32 v55, v56, v57
    s_waitcnt lgkmcnt(4)
    v_mfma_f32_16x16x32_bf16 v[20:23], v[76:79], v[44:47], v[20:23]
    ds_read_b64_tr_b16 v[40:41], v2 offset:6144
    v_cvt_pk_bf16_f32 v56, v58, v59
    v_mfma_f32_16x16x32_bf16 v[24:27], v[80:83], v[44:47], v[24:27]
    ds_read_b64_tr_b16 v[42:43], v2 offset:7168
    v_permlane32_swap_b32 v48, v50
    v_permlane32_swap_b32 v49, v51
    v_mfma_f32_16x16x32_bf16 v[28:31], v[84:87], v[44:47], v[28:31]
    buffer_store_dwordx4 v[48:51], v4, s[12:15], s21 offen sc0 sc1
    v_permlane16_swap_b32 v56, v57
    s_waitcnt lgkmcnt(4)
    v_mfma_f32_16x16x32_bf16 v[8:11], v[88:91], v[32:35], v[8:11]
    ds_read_b64_tr_b16 v[44:45], v3 offset:6144
    v_mfma_f32_16x16x32_bf16 v[12:15], v[92:95], v[32:35], v[12:15]
    ds_read_b64_tr_b16 v[46:47], v3 offset:7168
    v_permlane32_swap_b32 v54, v56
    v_permlane32_swap_b32 v55, v57
    v_mfma_f32_16x16x32_bf16 v[16:19], v[96:99], v[32:35], v[16:19]
    buffer_store_dwordx4 v[54:57], v4, s[12:15], s20 offen sc0 sc1
    s_waitcnt lgkmcnt(4)
    v_mfma_f32_16x16x32_bf16 v[20:23], v[88:91], v[36:39], v[20:23]
    s_waitcnt vmcnt(6)
    s_barrier
    ds_read_b64_tr_b16 v[32:33], v2 offset:8192
    v_mfma_f32_16x16x32_bf16 v[24:27], v[92:95], v[36:39], v[24:27]
    ds_read_b64_tr_b16 v[34:35], v2 offset:9216
    v_mfma_f32_16x16x32_bf16 v[28:31], v[96:99], v[36:39], v[28:31]
    buffer_load_dwordx4 v7, s[12:15], s27 offen sc1 lds
    s_waitcnt lgkmcnt(4)
    v_mfma_f32_16x16x32_bf16 v[8:11], v[100:103], v[40:43], v[8:11]
    ds_read_b64_tr_b16 v[36:37], v3 offset:8192
    v_mfma_f32_16x16x32_bf16 v[12:15], v[104:107], v[40:43], v[12:15]
    ds_read_b64_tr_b16 v[38:39], v3 offset:9216
    v_mfma_f32_16x16x32_bf16 v[16:19], v[108:111], v[40:43], v[16:19]
    s_waitcnt lgkmcnt(4)
    v_mfma_f32_16x16x32_bf16 v[20:23], v[100:103], v[44:47], v[20:23]
    ds_read_b64_tr_b16 v[40:41], v2 offset:10240
    v_mfma_f32_16x16x32_bf16 v[24:27], v[104:107], v[44:47], v[24:27]
    ds_read_b64_tr_b16 v[42:43], v2 offset:11264
    v_mfma_f32_16x16x32_bf16 v[28:31], v[108:111], v[44:47], v[28:31]
    s_waitcnt lgkmcnt(4)
    v_mfma_f32_16x16x32_bf16 v[8:11], v[112:115], v[32:35], v[8:11]
    ds_read_b64_tr_b16 v[44:45], v3 offset:10240
    v_mfma_f32_16x16x32_bf16 v[12:15], v[116:119], v[32:35], v[12:15]
    ds_read_b64_tr_b16 v[46:47], v3 offset:11264
    v_mfma_f32_16x16x32_bf16 v[16:19], v[120:123], v[32:35], v[16:19]
    buffer_load_dwordx4 v7, s[12:15], s27 offen offset:1024 sc1 lds
    s_add_u32 m0, m0, 8192
    s_add_u32 s27, s27, 8192
    s_waitcnt lgkmcnt(4)
    v_mfma_f32_16x16x32_bf16 v[20:23], v[112:115], v[36:39], v[20:23]
    ds_read_b64_tr_b16 v[32:33], v2 offset:12288
    v_mfma_f32_16x16x32_bf16 v[24:27], v[116:119], v[36:39], v[24:27]
    ds_read_b64_tr_b16 v[34:35], v2 offset:13312
    v_mfma_f32_16x16x32_bf16 v[28:31], v[120:123], v[36:39], v[28:31]
    s_waitcnt lgkmcnt(4)
    v_mfma_f32_16x16x32_bf16 v[8:11], v[124:127], v[40:43], v[8:11]
    ds_read_b64_tr_b16 v[36:37], v3 offset:12288
    v_mfma_f32_16x16x32_bf16 v[12:15], v[128:131], v[40:43], v[12:15]
    ds_read_b64_tr_b16 v[38:39], v3 offset:13312
    v_mfma_f32_16x16x32_bf16 v[16:19], v[132:135], v[40:43], v[16:19]
    s_waitcnt lgkmcnt(4)
    v_mfma_f32_16x16x32_bf16 v[20:23], v[124:127], v[44:47], v[20:23]
    ds_read_b64_tr_b16 v[40:41], v2 offset:14336
    v_mfma_f32_16x16x32_bf16 v[24:27], v[128:131], v[44:47], v[24:27]
    ds_read_b64_tr_b16 v[42:43], v2 offset:15360
    v_mfma_f32_16x16x32_bf16 v[28:31], v[132:135], v[44:47], v[28:31]
    buffer_load_dwordx4 v7, s[12:15], s27 offen sc1 lds
    s_waitcnt lgkmcnt(4)
    v_mfma_f32_16x16x32_bf16 v[8:11], v[136:139], v[32:35], v[8:11]
    ds_read_b64_tr_b16 v[44:45], v3 offset:14336
    v_mfma_f32_16x16x32_bf16 v[12:15], v[140:143], v[32:35], v[12:15]
    ds_read_b64_tr_b16 v[46:47], v3 offset:15360
    v_mfma_f32_16x16x32_bf16 v[16:19], v[144:147], v[32:35], v[16:19]
    s_waitcnt lgkmcnt(4)
    v_mfma_f32_16x16x32_bf16 v[20:23], v[136:139], v[36:39], v[20:23]
    s_waitcnt vmcnt(7)
    s_barrier
    ds_read_b64_tr_b16 v[32:33], v2 offset:16384
    v_mfma_f32_16x16x32_bf16 v[24:27], v[140:143], v[36:39], v[24:27]
    ds_read_b64_tr_b16 v[34:35], v2 offset:17408
    v_mfma_f32_16x16x32_bf16 v[28:31], v[144:147], v[36:39], v[28:31]
    s_waitcnt lgkmcnt(4)
    v_mfma_f32_16x16x32_bf16 v[8:11], v[148:151], v[40:43], v[8:11]
    ds_read_b64_tr_b16 v[36:37], v3 offset:16384
    v_mfma_f32_16x16x32_bf16 v[12:15], v[152:155], v[40:43], v[12:15]
    ds_read_b64_tr_b16 v[38:39], v3 offset:17408
    v_mfma_f32_16x16x32_bf16 v[16:19], v[156:159], v[40:43], v[16:19]
    s_waitcnt lgkmcnt(4)
    v_mfma_f32_16x16x32_bf16 v[20:23], v[148:151], v[44:47], v[20:23]
    ds_read_b64_tr_b16 v[40:41], v2 offset:18432
    v_mfma_f32_16x16x32_bf16 v[24:27], v[152:155], v[44:47], v[24:27]
    ds_read_b64_tr_b16 v[42:43], v2 offset:19456
    v_mfma_f32_16x16x32_bf16 v[28:31], v[156:159], v[44:47], v[28:31]
    buffer_load_dwordx4 v7, s[12:15], s27 offen offset:1024 sc1 lds
    s_add_u32 m0, m0, 8192
    s_add_u32 s27, s27, 8192
    s_waitcnt lgkmcnt(4)
    v_mfma_f32_16x16x32_bf16 v[8:11], v[160:163], v[32:35], v[8:11]
    ds_read_b64_tr_b16 v[44:45], v3 offset:18432
    v_mfma_f32_16x16x32_bf16 v[12:15], v[164:167], v[32:35], v[12:15]
    ds_read_b64_tr_b16 v[46:47], v3 offset:19456
    v_mfma_f32_16x16x32_bf16 v[16:19], v[168:171], v[32:35], v[16:19]
    s_waitcnt lgkmcnt(4)
    v_mfma_f32_16x16x32_bf16 v[20:23], v[160:163], v[36:39], v[20:23]
    ds_read_b64_tr_b16 v[32:33], v2 offset:20480
    v_mfma_f32_16x16x32_bf16 v[24:27], v[164:167], v[36:39], v[24:27]
    ds_read_b64_tr_b16 v[34:35], v2 offset:21504
    v_mfma_f32_16x16x32_bf16 v[28:31], v[168:171], v[36:39], v[28:31]
    s_waitcnt lgkmcnt(4)
    v_mfma_f32_16x16x32_bf16 v[8:11], v[172:175], v[40:43], v[8:11]
    ds_read_b64_tr_b16 v[36:37], v3 offset:20480
    v_mfma_f32_16x16x32_bf16 v[12:15], v[176:179], v[40:43], v[12:15]
    ds_read_b64_tr_b16 v[38:39], v3 offset:21504
    v_mfma_f32_16x16x32_bf16 v[16:19], v[180:183], v[40:43], v[16:19]
    s_waitcnt lgkmcnt(4)
    v_mfma_f32_16x16x32_bf16 v[20:23], v[172:175], v[44:47], v[20:23]
    ds_read_b64_tr_b16 v[40:41], v2 offset:22528
    v_mfma_f32_16x16x32_bf16 v[24:27], v[176:179], v[44:47], v[24:27]
    ds_read_b64_tr_b16 v[42:43], v2 offset:23552
    v_mfma_f32_16x16x32_bf16 v[28:31], v[180:183], v[44:47], v[28:31]
    buffer_load_dwordx4 v7, s[12:15], s27 offen sc1 lds
    s_waitcnt lgkmcnt(4)
    v_mfma_f32_16x16x32_bf16 v[8:11], v[184:187], v[32:35], v[8:11]
    ds_read_b64_tr_b16 v[44:45], v3 offset:22528
    v_mfma_f32_16x16x32_bf16 v[12:15], v[188:191], v[32:35], v[12:15]
    ds_read_b64_tr_b16 v[46:47], v3 offset:23552
    v_mfma_f32_16x16x32_bf16 v[16:19], v[192:195], v[32:35], v[16:19]
    s_waitcnt lgkmcnt(4)
    v_mfma_f32_16x16x32_bf16 v[20:23], v[184:187], v[36:39], v[20:23]
    s_waitcnt vmcnt(5)
    s_barrier
    s_mov_b64 exec, 0xffff
    buffer_store_dword v61, v6, s[12:15], s22 offen sc0 sc1
    s_mov_b64 exec, -1
    ds_read_b64_tr_b16 v[32:33], v2 offset:24576
    v_mfma_f32_16x16x32_bf16 v[24:27], v[188:191], v[36:39], v[24:27]
    ds_read_b64_tr_b16 v[34:35], v2 offset:25600
    v_mfma_f32_16x16x32_bf16 v[28:31], v[192:195], v[36:39], v[28:31]
    s_waitcnt lgkmcnt(4)
    v_mfma_f32_16x16x32_bf16 v[8:11], v[196:199], v[40:43], v[8:11]
    ds_read_b64_tr_b16 v[36:37], v3 offset:24576
    v_mfma_f32_16x16x32_bf16 v[12:15], v[200:203], v[40:43], v[12:15]
    ds_read_b64_tr_b16 v[38:39], v3 offset:25600
    v_mfma_f32_16x16x32_bf16 v[16:19], v[204:207], v[40:43], v[16:19]
    s_waitcnt lgkmcnt(4)
    v_mfma_f32_16x16x32_bf16 v[20:23], v[196:199], v[44:47], v[20:23]
    ds_read_b64_tr_b16 v[40:41], v2 offset:26624
    v_mfma_f32_16x16x32_bf16 v[24:27], v[200:203], v[44:47], v[24:27]
    ds_read_b64_tr_b16 v[42:43], v2 offset:27648
    v_mfma_f32_16x16x32_bf16 v[28:31], v[204:207], v[44:47], v[28:31]
    buffer_load_dwordx4 v7, s[12:15], s27 offen offset:1024 sc1 lds
    s_add_u32 m0, m0, 8192
    s_add_u32 s27, s27, 8192
    s_waitcnt lgkmcnt(4)
    v_mfma_f32_16x16x32_bf16 v[8:11], v[208:211], v[32:35], v[8:11]
    ds_read_b64_tr_b16 v[44:45], v3 offset:26624
    v_mfma_f32_16x16x32_bf16 v[12:15], v[212:215], v[32:35], v[12:15]
    ds_read_b64_tr_b16 v[46:47], v3 offset:27648
    v_mfma_f32_16x16x32_bf16 v[16:19], v[216:219], v[32:35], v[16:19]
    s_waitcnt lgkmcnt(4)
    v_mfma_f32_16x16x32_bf16 v[20:23], v[208:211], v[36:39], v[20:23]
    ds_read_b64_tr_b16 v[32:33], v2 offset:28672
    v_mfma_f32_16x16x32_bf16 v[24:27], v[212:215], v[36:39], v[24:27]
    ds_read_b64_tr_b16 v[34:35], v2 offset:29696
    v_mfma_f32_16x16x32_bf16 v[28:31], v[216:219], v[36:39], v[28:31]
    s_waitcnt lgkmcnt(4)
    v_mfma_f32_16x16x32_bf16 v[8:11], v[220:223], v[40:43], v[8:11]
    ds_read_b64_tr_b16 v[36:37], v3 offset:28672
    v_mfma_f32_16x16x32_bf16 v[12:15], v[224:227], v[40:43], v[12:15]
    ds_read_b64_tr_b16 v[38:39], v3 offset:29696
    v_mfma_f32_16x16x32_bf16 v[16:19], v[228:231], v[40:43], v[16:19]
    s_waitcnt lgkmcnt(4)
    v_mfma_f32_16x16x32_bf16 v[20:23], v[220:223], v[44:47], v[20:23]
    ds_read_b64_tr_b16 v[40:41], v2 offset:30720
    v_mfma_f32_16x16x32_bf16 v[24:27], v[224:227], v[44:47], v[24:27]
    ds_read_b64_tr_b16 v[42:43], v2 offset:31744
    v_mfma_f32_16x16x32_bf16 v[28:31], v[228:231], v[44:47], v[28:31]
    buffer_load_dwordx4 v7, s[12:15], s27 offen sc1 lds
    s_waitcnt lgkmcnt(4)
    v_mfma_f32_16x16x32_bf16 v[8:11], v[232:235], v[32:35], v[8:11]
    ds_read_b64_tr_b16 v[44:45], v3 offset:30720
    v_mfma_f32_16x16x32_bf16 v[12:15], v[236:239], v[32:35], v[12:15]
    ds_read_b64_tr_b16 v[46:47], v3 offset:31744
    v_mfma_f32_16x16x32_bf16 v[16:19], v[240:243], v[32:35], v[16:19]
    s_waitcnt lgkmcnt(4)
    v_mfma_f32_16x16x32_bf16 v[20:23], v[232:235], v[36:39], v[20:23]
    s_waitcnt vmcnt(6)
    s_barrier
    ds_read_b64_tr_b16 v[32:33], v2 offset:32768
    v_mfma_f32_16x16x32_bf16 v[24:27], v[236:239], v[36:39], v[24:27]
    ds_read_b64_tr_b16 v[34:35], v2 offset:33792
    v_mfma_f32_16x16x32_bf16 v[28:31], v[240:243], v[36:39], v[28:31]
    s_waitcnt lgkmcnt(4)
    v_mfma_f32_16x16x32_bf16 v[8:11], v[244:247], v[40:43], v[8:11]
    ds_read_b64_tr_b16 v[36:37], v3 offset:32768
    v_mfma_f32_16x16x32_bf16 v[12:15], v[248:251], v[40:43], v[12:15]
    ds_read_b64_tr_b16 v[38:39], v3 offset:33792
    v_mfma_f32_16x16x32_bf16 v[16:19], v[252:255], v[40:43], v[16:19]
    buffer_load_dwordx4 v7, s[12:15], s27 offen offset:1024 sc1 lds
    s_add_u32 m0, m0, 8192
    s_add_u32 s27, s27, 8192
    s_waitcnt lgkmcnt(4)
    v_mfma_f32_16x16x32_bf16 v[20:23], v[244:247], v[44:47], v[20:23]
    ds_read_b64_tr_b16 v[40:41], v2 offset:34816
    v_mfma_f32_16x16x32_bf16 v[24:27], v[248:251], v[44:47], v[24:27]
    ds_read_b64_tr_b16 v[42:43], v2 offset:35840
    v_mfma_f32_16x16x32_bf16 v[28:31], v[252:255], v[44:47], v[28:31]
    v_lshl_or_b32 v61, v61, 1, 1
    s_mov_b32 s21, s19
    s_mov_b32 s22, s48
    s_bitcmp0_b32 s8, 0
    s_cbranch_scc1 Lu_last
    s_mov_b32 s27, s18
    s_mov_b32 m0, s23
    s_mov_b64 s[28:29], 0
    s_mov_b64 s[40:41], -1
    s_waitcnt lgkmcnt(4)
    v_mul_f32 v48, v8, v12
    v_mul_f32 v49, v9, v13
    v_mul_f32 v50, v10, v14
    v_mul_f32 v51, v11, v15
    v_mfma_f32_16x16x32_bf16 v[8:11], v[64:67], v[32:35], 0
    s_add_u32 s20, s21, 92160
    ds_read_b64_tr_b16 v[44:45], v3 offset:34816
    v_mfma_f32_16x16x32_bf16 v[12:15], v[68:71], v[32:35], 0
    ds_read_b64_tr_b16 v[46:47], v3 offset:35840
    v_mul_f32 v52, v16, v18
    v_mul_f32 v53, v17, v19
    v_mfma_f32_16x16x32_bf16 v[16:19], v[72:75], v[32:35], 0
    s_waitcnt lgkmcnt(4)
    v_mul_f32 v54, v20, v24
    v_mul_f32 v55, v21, v25
    v_mul_f32 v56, v22, v26
    v_mul_f32 v57, v23, v27
    v_mfma_f32_16x16x32_bf16 v[20:23], v[64:67], v[36:39], 0
    ds_read_b64_tr_b16 v[32:33], v2 offset:36864
    v_cmp_u_f32 vcc, v48, v54
    v_mfma_f32_16x16x32_bf16 v[24:27], v[68:71], v[36:39], 0
    ds_read_b64_tr_b16 v[34:35], v2 offset:37888
    v_mul_f32 v58, v28, v30
    v_mul_f32 v59, v29, v31
    s_cbranch_vccnz Lu_rd1
Lu_bk1:
    v_mfma_f32_16x16x32_bf16 v[28:31], v[72:75], v[36:39], 0
    s_waitcnt lgkmcnt(4)
    v_mfma_f32_16x16x32_bf16 v[8:11], v[76:79], v[40:43], v[8:11]
    ds_read_b64_tr_b16 v[36:37], v3 offset:36864
    v_cvt_pk_bf16_f32 v48, v48, v49
    v_cvt_pk_bf16_f32 v49, v50, v51
    v_mfma_f32_16x16x32_bf16 v[12:15], v[80:83], v[40:43], v[12:15]
    ds_read_b64_tr_b16 v[38:39], v3 offset:37888
    v_cvt_pk_bf16_f32 v50, v52, v53
    v_cvt_pk_bf16_f32 v54, v54, v55
    v_mfma_f32_16x16x32_bf16 v[16:19], v[84:87], v[40:43], v[16:19]
    v_permlane16_swap_b32 v50, v51
    v_cvt_pk_bf16_f32 v55, v56, v57
    s_waitcnt lgkmcnt(4)
    v_mfma_f32_16x16x32_bf16 v[20:23], v[76:79], v[44:47], v[20:23]
    ds_read_b64_tr_b16 v[40:41], v2 offset:38912
    v_cvt_pk_bf16_f32 v56, v58, v59
    v_mfma_f32_16x16x32_bf16 v[24:27], v[80:83], v[44:47], v[24:27]
    ds_read_b64_tr_b16 v[42:43], v2 offset:39936
    v_permlane32_swap_b32 v48, v50
    v_permlane32_swap_b32 v49, v51
    v_mfma_f32_16x16x32_bf16 v[28:31], v[84:87], v[44:47], v[28:31]
    buffer_store_dwordx4 v[48:51], v4, s[12:15], s21 offen sc0 sc1
    v_permlane16_swap_b32 v56, v57
    s_waitcnt lgkmcnt(4)
    v_mfma_f32_16x16x32_bf16 v[8:11], v[88:91], v[32:35], v[8:11]
    ds_read_b64_tr_b16 v[44:45], v3 offset:38912
    v_mfma_f32_16x16x32_bf16 v[12:15], v[92:95], v[32:35], v[12:15]
    ds_read_b64_tr_b16 v[46:47], v3 offset:39936
    v_permlane32_swap_b32 v54, v56
    v_permlane32_swap_b32 v55, v57
    v_mfma_f32_16x16x32_bf16 v[16:19], v[96:99], v[32:35], v[16:19]
    buffer_store_dwordx4 v[54:57], v4, s[12:15], s20 offen sc0 sc1
    s_waitcnt lgkmcnt(4)
    v_mfma_f32_16x16x32_bf16 v[20:23], v[88:91], v[36:39], v[20:23]
    s_waitcnt vmcnt(7)
    s_barrier
    ds_read_b64_tr_b16 v[32:33], v2 offset:40960
    v_mfma_f32_16x16x32_bf16 v[24:27], v[92:95], v[36:39], v[24:27]
    ds_read_b64_tr_b16 v[34:35], v2 offset:41984
    v_mfma_f32_16x16x32_bf16 v[28:31], v[96:99], v[36:39], v[28:31]
    s_waitcnt lgkmcnt(4)
    v_mfma_f32_16x16x32_bf16 v[8:11], v[100:103], v[40:43], v[8:11]
    ds_read_b64_tr_b16 v[36:37], v3 offset:40960
    v_mfma_f32_16x16x32_bf16 v[12:15], v[104:107], v[40:43], v[12:15]
    ds_read_b64_tr_b16 v[38:39], v3 offset:41984
    v_mfma_f32_16x16x32_bf16 v[16:19], v[108:111], v[40:43], v[16:19]
    s_waitcnt lgkmcnt(4)
    v_mfma_f32_16x16x32_bf16 v[20:23], v[100:103], v[44:47], v[20:23]
    ds_read_b64_tr_b16 v[40:41], v2 offset:43008
    v_mfma_f32_16x16x32_bf16 v[24:27], v[104:107], v[44:47], v[24:27]
    ds_read_b64_tr_b16 v[42:43], v2 offset:44032
    v_mfma_f32_16x16x32_bf16 v[28:31], v[108:111], v[44:47], v[28:31]
    s_waitcnt lgkmcnt(4)
    v_mfma_f32_16x16x32_bf16 v[8:11], v[112:115], v[32:35], v[8:11]
    ds_read_b64_tr_b16 v[44:45], v3 offset:43008
    v_mfma_f32_16x16x32_bf16 v[12:15], v[116:119], v[32:35], v[12:15]
    ds_read_b64_tr_b16 v[46:47], v3 offset:44032
    v_mfma_f32_16x16x32_bf16 v[16:19], v[120:123], v[32:35], v[16:19]
    s_waitcnt lgkmcnt(4)
    v_mfma_f32_16x16x32_bf16 v[20:23], v[112:115], v[36:39], v[20:23]
    ds_read_b64_tr_b16 v[32:33], v2 offset:45056
    v_mfma_f32_16x16x32_bf16 v[24:27], v[116:119], v[36:39], v[24:27]
    ds_read_b64_tr_b16 v[34:35], v2 offset:46080
    v_mfma_f32_16x16x32_bf16 v[28:31], v[120:123], v[36:39], v[28:31]
    s_buffer_load_dwordx2 s[28:29], s[12:15], s46 glc
    s_waitcnt lgkmcnt(4)
    v_mfma_f32_16x16x32_bf16 v[8:11], v[124:127], v[40:43], v[8:11]
    ds_read_b64_tr_b16 v[36:37], v3 offset:45056
    v_mfma_f32_16x16x32_bf16 v[12:15], v[128:131], v[40:43], v[12:15]
    ds_read_b64_tr_b16 v[38:39], v3 offset:46080
    v_mfma_f32_16x16x32_bf16 v[16:19], v[132:135], v[40:43], v[16:19]
    s_waitcnt lgkmcnt(4)
    v_mfma_f32_16x16x32_bf16 v[20:23], v[124:127], v[44:47], v[20:23]
    ds_read_b64_tr_b16 v[40:41], v2 offset:47104
    v_mfma_f32_16x16x32_bf16 v[24:27], v[128:131], v[44:47], v[24:27]
    ds_read_b64_tr_b16 v[42:43], v2 offset:48128
    v_mfma_f32_16x16x32_bf16 v[28:31], v[132:135], v[44:47], v[28:31]
    s_waitcnt lgkmcnt(4)
    v_mfma_f32_16x16x32_bf16 v[8:11], v[136:139], v[32:35], v[8:11]
    ds_read_b64_tr_b16 v[44:45], v3 offset:47104
    v_mfma_f32_16x16x32_bf16 v[12:15], v[140:143], v[32:35], v[12:15]
    ds_read_b64_tr_b16 v[46:47], v3 offset:48128
    v_mfma_f32_16x16x32_bf16 v[16:19], v[144:147], v[32:35], v[16:19]
    s_waitcnt lgkmcnt(4)
    v_mfma_f32_16x16x32_bf16 v[20:23], v[136:139], v[36:39], v[20:23]
    s_waitcnt vmcnt(4)
    s_barrier
    ds_read_b64_tr_b16 v[32:33], v2 offset:49152
    v_mfma_f32_16x16x32_bf16 v[24:27], v[140:143], v[36:39], v[24:27]
    ds_read_b64_tr_b16 v[34:35], v2 offset:50176
    v_mfma_f32_16x16x32_bf16 v[28:31], v[144:147], v[36:39], v[28:31]
    s_waitcnt lgkmcnt(4)
    v_mfma_f32_16x16x32_bf16 v[8:11], v[148:151], v[40:43], v[8:11]
    ds_read_b64_tr_b16 v[36:37], v3 offset:49152
    v_mfma_f32_16x16x32_bf16 v[12:15], v[152:155], v[40:43], v[12:15]
    ds_read_b64_tr_b16 v[38:39], v3 offset:50176
    v_mfma_f32_16x16x32_bf16 v[16:19], v[156:159], v[40:43], v[16:19]
    s_waitcnt lgkmcnt(4)
    v_mfma_f32_16x16x32_bf16 v[20:23], v[148:151], v[44:47], v[20:23]
    ds_read_b64_tr_b16 v[40:41], v2 offset:51200
    v_mfma_f32_16x16x32_bf16 v[24:27], v[152:155], v[44:47], v[24:27]
    ds_read_b64_tr_b16 v[42:43], v2 offset:52224
    v_mfma_f32_16x16x32_bf16 v[28:31], v[156:159], v[44:47], v[28:31]
    s_buffer_load_dwordx2 s[28:29], s[12:15], s46 glc
    s_waitcnt lgkmcnt(4)
    v_mfma_f32_16x16x32_bf16 v[8:11], v[160:163], v[32:35], v[8:11]
    ds_read_b64_tr_b16 v[44:45], v3 offset:51200
    v_mfma_f32_16x16x32_bf16 v[12:15], v[164:167], v[32:35], v[12:15]
    ds_read_b64_tr_b16 v[46:47], v3 offset:52224
    v_mfma_f32_16x16x32_bf16 v[16:19], v[168:171], v[32:35], v[16:19]
    s_waitcnt lgkmcnt(4)
    v_mfma_f32_16x16x32_bf16 v[20:23], v[160:163], v[36:39], v[20:23]
    s_waitcnt vmcnt(0)
    s_barrier
    s_mov_b64 exec, 0xffff
    buffer_store_dword v61, v6, s[12:15], s22 offen sc0 sc1
    s_mov_b64 exec, -1
    ds_read_b64_tr_b16 v[32:33], v2 offset:53248
    v_mfma_f32_16x16x32_bf16 v[24:27], v[164:167], v[36:39], v[24:27]
    ds_read_b64_tr_b16 v[34:35], v2 offset:54272
    s_cmp_eq_u64 s[28:29], s[40:41]
    s_cbranch_scc1 Lu_dp17
Lu_np17:
    v_mfma_f32_16x16x32_bf16 v[28:31], v[168:171], v[36:39], v[28:31]
    s_waitcnt lgkmcnt(4)
    v_mfma_f32_16x16x32_bf16 v[8:11], v[172:175], v[40:43], v[8:11]
    ds_read_b64_tr_b16 v[36:37], v3 offset:53248
    v_mfma_f32_16x16x32_bf16 v[12:15], v[176:179], v[40:43], v[12:15]
    ds_read_b64_tr_b16 v[38:39], v3 offset:54272
    s_cmp_eq_u64 s[28:29], s[40:41]
    s_cbranch_scc1 Lu_dp18
Lu_np18:
    v_mfma_f32_16x16x32_bf16 v[16:19], v[180:183], v[40:43], v[16:19]
    s_waitcnt lgkmcnt(4)
    v_mfma_f32_16x16x32_bf16 v[20:23], v[172:175], v[44:47], v[20:23]
    ds_read_b64_tr_b16 v[40:41], v2 offset:55296
    v_mfma_f32_16x16x32_bf16 v[24:27], v[176:179], v[44:47], v[24:27]
    ds_read_b64_tr_b16 v[42:43], v2 offset:56320
    s_cmp_eq_u64 s[28:29], s[40:41]
    s_cbranch_scc1 Lu_dp19
Lu_np19:
    v_mfma_f32_16x16x32_bf16 v[28:31], v[180:183], v[44:47], v[28:31]
    s_waitcnt lgkmcnt(4)
    v_mfma_f32_16x16x32_bf16 v[8:11], v[184:187], v[32:35], v[8:11]
    ds_read_b64_tr_b16 v[44:45], v3 offset:55296
    v_mfma_f32_16x16x32_bf16 v[12:15], v[188:191], v[32:35], v[12:15]
    ds_read_b64_tr_b16 v[46:47], v3 offset:56320
    s_cmp_eq_u64 s[28:29], s[40:41]
    s_cbranch_scc1 Lu_dp20
Lu_np20:
    v_mfma_f32_16x16x32_bf16 v[16:19], v[192:195], v[32:35], v[16:19]
    s_waitcnt lgkmcnt(4)
    v_mfma_f32_16x16x32_bf16 v[20:23], v[184:187], v[36:39], v[20:23]
    ds_read_b64_tr_b16 v[32:33], v2 offset:57344
    v_mfma_f32_16x16x32_bf16 v[24:27], v[188:191], v[36:39], v[24:27]
    ds_read_b64_tr_b16 v[34:35], v2 offset:58368
    s_cmp_eq_u64 s[28:29], s[40:41]
    s_cbranch_scc1 Lu_dp21
Lu_np21:
    v_mfma_f32_16x16x32_bf16 v[28:31], v[192:195], v[36:39], v[28:31]
    s_buffer_load_dwordx2 s[28:29], s[12:15], s46 glc
    s_waitcnt lgkmcnt(4)
    v_mfma_f32_16x16x32_bf16 v[8:11], v[196:199], v[40:43], v[8:11]
    ds_read_b64_tr_b16 v[36:37], v3 offset:57344
    v_mfma_f32_16x16x32_bf16 v[12:15], v[200:203], v[40:43], v[12:15]
    ds_read_b64_tr_b16 v[38:39], v3 offset:58368
    s_cmp_eq_u64 s[28:29], s[40:41]
    s_cbranch_scc1 Lu_dp22
Lu_np22:
    v_mfma_f32_16x16x32_bf16 v[16:19], v[204:207], v[40:43], v[16:19]
    s_waitcnt lgkmcnt(4)
    v_mfma_f32_16x16x32_bf16 v[20:23], v[196:199], v[44:47], v[20:23]
    ds_read_b64_tr_b16 v[40:41], v2 offset:59392
    v_mfma_f32_16x16x32_bf16 v[24:27], v[200:203], v[44:47], v[24:27]
    ds_read_b64_tr_b16 v[42:43], v2 offset:60416
    s_cmp_eq_u64 s[28:29], s[40:41]
    s_cbranch_scc1 Lu_dp23
Lu_np23:
    v_mfma_f32_16x16x32_bf16 v[28:31], v[204:207], v[44:47], v[28:31]
    s_waitcnt lgkmcnt(4)
    v_mfma_f32_16x16x32_bf16 v[8:11], v[208:211], v[32:35], v[8:11]
    ds_read_b64_tr_b16 v[44:45], v3 offset:59392
    v_mfma_f32_16x16x32_bf16 v[12:15], v[212:215], v[32:35], v[12:15]
    ds_read_b64_tr_b16 v[46:47], v3 offset:60416
    s_cmp_eq_u64 s[28:29], s[40:41]
    s_cbranch_scc1 Lu_dp24
Lu_np24:
    v_mfma_f32_16x16x32_bf16 v[16:19], v[216:219], v[32:35], v[16:19]
    s_waitcnt lgkmcnt(4)
    v_mfma_f32_16x16x32_bf16 v[20:23], v[208:211], v[36:39], v[20:23]
    ds_read_b64_tr_b16 v[32:33], v2 offset:61440
    v_mfma_f32_16x16x32_bf16 v[24:27], v[212:215], v[36:39], v[24:27]
    ds_read_b64_tr_b16 v[34:35], v2 offset:62464
    s_cmp_eq_u64 s[28:29], s[40:41]
    s_cbranch_scc1 Lu_dp25
Lu_np25:
    v_mfma_f32_16x16x32_bf16 v[28:31], v[216:219], v[36:39], v[28:31]
    s_waitcnt lgkmcnt(4)
    v_mfma_f32_16x16x32_bf16 v[8:11], v[220:223], v[40:43], v[8:11]
    ds_read_b64_tr_b16 v[36:37], v3 offset:61440
    v_mfma_f32_16x16x32_bf16 v[12:15], v[224:227], v[40:43], v[12:15]
    ds_read_b64_tr_b16 v[38:39], v3 offset:62464
    s_cmp_eq_u64 s[28:29], s[40:41]
    s_cbranch_scc1 Lu_dp26
Lu_np26:
    v_mfma_f32_16x16x32_bf16 v[16:19], v[228:231], v[40:43], v[16:19]
    s_waitcnt lgkmcnt(4)
    v_mfma_f32_16x16x32_bf16 v[20:23], v[220:223], v[44:47], v[20:23]
    ds_read_b64_tr_b16 v[40:41], v2 offset:63488
    v_mfma_f32_16x16x32_bf16 v[24:27], v[224:227], v[44:47], v[24:27]
    ds_read_b64_tr_b16 v[42:43], v2 offset:64512
    s_cmp_eq_u64 s[28:29], s[40:41]
    s_cbranch_scc1 Lu_dp27
Lu_np27:
    v_mfma_f32_16x16x32_bf16 v[28:31], v[228:231], v[44:47], v[28:31]
    s_waitcnt lgkmcnt(4)
    v_mfma_f32_16x16x32_bf16 v[8:11], v[232:235], v[32:35], v[8:11]
    ds_read_b64_tr_b16 v[44:45], v3 offset:63488
    v_mfma_f32_16x16x32_bf16 v[12:15], v[236:239], v[32:35], v[12:15]
    ds_read_b64_tr_b16 v[46:47], v3 offset:64512
    s_cmp_eq_u64 s[28:29], s[40:41]
    s_cbranch_scc1 Lu_dp28
Lu_np28:
    v_mfma_f32_16x16x32_bf16 v[16:19], v[240:243], v[32:35], v[16:19]
    s_waitcnt lgkmcnt(4)
    v_mfma_f32_16x16x32_bf16 v[20:23], v[232:235], v[36:39], v[20:23]
    s_cmp_lt_u32 m0, s25
    s_cbranch_scc1 Lu_blk
Lu_rdy:
    s_waitcnt vmcnt(6)
    s_barrier
    ds_read_b64_tr_b16 v[32:33], v2 offset:0
    v_mfma_f32_16x16x32_bf16 v[24:27], v[236:239], v[36:39], v[24:27]
    ds_read_b64_tr_b16 v[34:35], v2 offset:1024
    v_mfma_f32_16x16x32_bf16 v[28:31], v[240:243], v[36:39], v[28:31]
    s_waitcnt lgkmcnt(4)
    v_mfma_f32_16x16x32_bf16 v[8:11], v[244:247], v[40:43], v[8:11]
    ds_read_b64_tr_b16 v[36:37], v3 offset:0
    v_mfma_f32_16x16x32_bf16 v[12:15], v[248:251], v[40:43], v[12:15]
    ds_read_b64_tr_b16 v[38:39], v3 offset:1024
    v_mfma_f32_16x16x32_bf16 v[16:19], v[252:255], v[40:43], v[16:19]
    s_waitcnt lgkmcnt(4)
    v_mfma_f32_16x16x32_bf16 v[20:23], v[244:247], v[44:47], v[20:23]
    ds_read_b64_tr_b16 v[40:41], v2 offset:2048
    v_mfma_f32_16x16x32_bf16 v[24:27], v[248:251], v[44:47], v[24:27]
    ds_read_b64_tr_b16 v[42:43], v2 offset:3072
    v_mfma_f32_16x16x32_bf16 v[28:31], v[252:255], v[44:47], v[28:31]
    v_lshl_or_b32 v61, v61, 1, 1
    s_add_u32 s21, s19, 46080
    s_add_u32 s19, s19, 2949120
    s_add_u32 s8, s8, 1
    s_branch Lu_even
Lu_dp17:
    buffer_load_dwordx4 v7, s[12:15], s27 offen sc1 lds
    buffer_load_dwordx4 v7, s[12:15], s27 offen offset:1024 sc1 lds
    s_add_u32 m0, m0, 8192
    s_add_u32 s27, s27, 8192
    s_cmp_ge_u32 m0, s25
    s_cselect_b32 s40, 1, s40
    s_branch Lu_np17
Lu_dp18:
    buffer_load_dwordx4 v7, s[12:15], s27 offen sc1 lds
    buffer_load_dwordx4 v7, s[12:15], s27 offen offset:1024 sc1 lds
    s_add_u32 m0, m0, 8192
    s_add_u32 s27, s27, 8192
    s_cmp_ge_u32 m0, s25
    s_cselect_b32 s40, 1, s40
    s_branch Lu_np18
Lu_dp19:
    buffer_load_dwordx4 v7, s[12:15], s27 offen sc1 lds
    buffer_load_dwordx4 v7, s[12:15], s27 offen offset:1024 sc1 lds
    s_add_u32 m0, m0, 8192
    s_add_u32 s27, s27, 8192
    s_cmp_ge_u32 m0, s25
    s_cselect_b32 s40, 1, s40
    s_branch Lu_np19
Lu_dp20:
    buffer_load_dwordx4 v7, s[12:15], s27 offen sc1 lds
    buffer_load_dwordx4 v7, s[12:15], s27 offen offset:1024 sc1 lds
    s_add_u32 m0, m0, 8192
    s_add_u32 s27, s27, 8192
    s_cmp_ge_u32 m0, s25
    s_cselect_b32 s40, 1, s40
    s_branch Lu_np20
Lu_dp21:
    buffer_load_dwordx4 v7, s[12:15], s27 offen sc1 lds
    buffer_load_dwordx4 v7, s[12:15], s27 offen offset:1024 sc1 lds
    s_add_u32 m0, m0, 8192
    s_add_u32 s27, s27, 8192
    s_cmp_ge_u32 m0, s25
    s_cselect_b32 s40, 1, s40
    s_branch Lu_np21
Lu_dp22:
    buffer_load_dwordx4 v7, s[12:15], s27 offen sc1 lds
    buffer_load_dwordx4 v7, s[12:15], s27 offen offset:1024 sc1 lds
    s_add_u32 m0, m0, 8192
    s_add_u32 s27, s27, 8192
    s_cmp_ge_u32 m0, s25
    s_cselect_b32 s40, 1, s40
    s_branch Lu_np22
Lu_dp23:
    buffer_load_dwordx4 v7, s[12:15], s27 offen sc1 lds
    buffer_load_dwordx4 v7, s[12:15], s27 offen offset:1024 sc1 lds
    s_add_u32 m0, m0, 8192
    s_add_u32 s27, s27, 8192
    s_cmp_ge_u32 m0, s25
    s_cselect_b32 s40, 1, s40
    s_branch Lu_np23
Lu_dp24:
    buffer_load_dwordx4 v7, s[12:15], s27 offen sc1 lds
    buffer_load_dwordx4 v7, s[12:15], s27 offen offset:1024 sc1 lds
    s_add_u32 m0, m0, 8192
    s_add_u32 s27, s27, 8192
    s_cmp_ge_u32 m0, s25
    s_cselect_b32 s40, 1, s40
    s_branch Lu_np24
Lu_dp25:
    buffer_load_dwordx4 v7, s[12:15], s27 offen sc1 lds
    buffer_load_dwordx4 v7, s[12:15], s27 offen offset:1024 sc1 lds
    s_add_u32 m0, m0, 8192
    s_add_u32 s27, s27, 8192
    s_cmp_ge_u32 m0, s25
    s_cselect_b32 s40, 1, s40
    s_branch Lu_np25
Lu_dp26:
    buffer_load_dwordx4 v7, s[12:15], s27 offen sc1 lds
    buffer_load_dwordx4 v7, s[12:15], s27 offen offset:1024 sc1 lds
    s_add_u32 m0, m0, 8192
    s_add_u32 s27, s27, 8192
    s_cmp_ge_u32 m0, s25
    s_cselect_b32 s40, 1, s40
    s_branch Lu_np26
Lu_dp27:
    buffer_load_dwordx4 v7, s[12:15], s27 offen sc1 lds
    buffer_load_dwordx4 v7, s[12:15], s27 offen offset:1024 sc1 lds
    s_add_u32 m0, m0, 8192
    s_add_u32 s27, s27, 8192
    s_cmp_ge_u32 m0, s25
    s_cselect_b32 s40, 1, s40
    s_branch Lu_np27
Lu_dp28:
    buffer_load_dwordx4 v7, s[12:15], s27 offen sc1 lds
    buffer_load_dwordx4 v7, s[12:15], s27 offen offset:1024 sc1 lds
    s_add_u32 m0, m0, 8192
    s_add_u32 s27, s27, 8192
    s_cmp_ge_u32 m0, s25
    s_cselect_b32 s40, 1, s40
    s_branch Lu_np28
Lu_blk:
    s_cmp_eq_u64 s[28:29], -1
    s_cbranch_scc1 Lu_lp
    s_branch Lu_pbe
Lu_pb:
    s_sleep 1
Lu_pbe:
    s_buffer_load_dwordx2 s[56:57], s[12:15], s46 glc
    s_sub_u32 s9, s9, 1
    s_cmp_lt_i32 s9, 0
    s_waitcnt lgkmcnt(0)
    s_cbranch_scc1 Lu_pbx
    s_cmp_lg_u64 s[56:57], -1
    s_cbranch_scc1 Lu_pb
Lu_pbx:
Lu_lp:
    buffer_load_dwordx4 v7, s[12:15], s27 offen sc1 lds
    buffer_load_dwordx4 v7, s[12:15], s27 offen offset:1024 sc1 lds
    s_add_u32 m0, m0, 8192
    s_add_u32 s27, s27, 8192
    s_cmp_lt_u32 m0, s25
    s_cbranch_scc1 Lu_lp
    s_branch Lu_rdy
Lu_last:
    s_waitcnt lgkmcnt(4)
    v_mul_f32 v48, v8, v12
    v_mul_f32 v49, v9, v13
    v_mul_f32 v50, v10, v14
    v_mul_f32 v51, v11, v15
    v_mfma_f32_16x16x32_bf16 v[8:11], v[64:67], v[32:35], 0
    s_add_u32 s20, s21, 92160
    ds_read_b64_tr_b16 v[44:45], v3 offset:34816
    v_mfma_f32_16x16x32_bf16 v[12:15], v[68:71], v[32:35], 0
    ds_read_b64_tr_b16 v[46:47], v3 offset:35840
    v_mul_f32 v52, v16, v18
    v_mul_f32 v53, v17, v19
    v_mfma_f32_16x16x32_bf16 v[16:19], v[72:75], v[32:35], 0
    s_waitcnt lgkmcnt(4)
    v_mul_f32 v54, v20, v24
    v_mul_f32 v55, v21, v25
    v_mul_f32 v56, v22, v26
    v_mul_f32 v57, v23, v27
    v_mfma_f32_16x16x32_bf16 v[20:23], v[64:67], v[36:39], 0
    ds_read_b64_tr_b16 v[32:33], v2 offset:36864
    v_cmp_u_f32 vcc, v48, v54
    v_mfma_f32_16x16x32_bf16 v[24:27], v[68:71], v[36:39], 0
    ds_read_b64_tr_b16 v[34:35], v2 offset:37888
    v_mul_f32 v58, v28, v30
    v_mul_f32 v59, v29, v31
    s_cbranch_vccnz Lu_rd2
Lu_bk2:
    v_mfma_f32_16x16x32_bf16 v[28:31], v[72:75], v[36:39], 0
    s_waitcnt lgkmcnt(4)
    v_mfma_f32_16x16x32_bf16 v[8:11], v[76:79], v[40:43], v[8:11]
    ds_read_b64_tr_b16 v[36:37], v3 offset:36864
    v_cvt_pk_bf16_f32 v48, v48, v49
    v_cvt_pk_bf16_f32 v49, v50, v51
    v_mfma_f32_16x16x32_bf16 v[12:15], v[80:83], v[40:43], v[12:15]
    ds_read_b64_tr_b16 v[38:39], v3 offset:37888
    v_cvt_pk_bf16_f32 v50, v52, v53
    v_cvt_pk_bf16_f32 v54, v54, v55
    v_mfma_f32_16x16x32_bf16 v[16:19], v[84:87], v[40:43], v[16:19]
    v_permlane16_swap_b32 v50, v51
    v_cvt_pk_bf16_f32 v55, v56, v57
    s_waitcnt lgkmcnt(4)
    v_mfma_f32_16x16x32_bf16 v[20:23], v[76:79], v[44:47], v[20:23]
    ds_read_b64_tr_b16 v[40:41], v2 offset:38912
    v_cvt_pk_bf16_f32 v56, v58, v59
    v_mfma_f32_16x16x32_bf16 v[24:27], v[80:83], v[44:47], v[24:27]
    ds_read_b64_tr_b16 v[42:43], v2 offset:39936
    v_permlane32_swap_b32 v48, v50
    v_permlane32_swap_b32 v49, v51
    v_mfma_f32_16x16x32_bf16 v[28:31], v[84:87], v[44:47], v[28:31]
    buffer_store_dwordx4 v[48:51], v4, s[12:15], s21 offen sc0 sc1
    v_permlane16_swap_b32 v56, v57
    s_waitcnt lgkmcnt(4)
    v_mfma_f32_16x16x32_bf16 v[8:11], v[88:91], v[32:35], v[8:11]
    ds_read_b64_tr_b16 v[44:45], v3 offset:38912
    v_mfma_f32_16x16x32_bf16 v[12:15], v[92:95], v[32:35], v[12:15]
    ds_read_b64_tr_b16 v[46:47], v3 offset:39936
    v_permlane32_swap_b32 v54, v56
    v_permlane32_swap_b32 v55, v57
    v_mfma_f32_16x16x32_bf16 v[16:19], v[96:99], v[32:35], v[16:19]
    buffer_store_dwordx4 v[54:57], v4, s[12:15], s20 offen sc0 sc1
    s_waitcnt lgkmcnt(4)
    v_mfma_f32_16x16x32_bf16 v[20:23], v[88:91], v[36:39], v[20:23]
    s_waitcnt vmcnt(7)
    s_barrier
    ds_read_b64_tr_b16 v[32:33], v2 offset:40960
    v_mfma_f32_16x16x32_bf16 v[24:27], v[92:95], v[36:39], v[24:27]
    ds_read_b64_tr_b16 v[34:35], v2 offset:41984
    v_mfma_f32_16x16x32_bf16 v[28:31], v[96:99], v[36:39], v[28:31]
    s_waitcnt lgkmcnt(4)
    v_mfma_f32_16x16x32_bf16 v[8:11], v[100:103], v[40:43], v[8:11]
    ds_read_b64_tr_b16 v[36:37], v3 offset:40960
    v_mfma_f32_16x16x32_bf16 v[12:15], v[104:107], v[40:43], v[12:15]
    ds_read_b64_tr_b16 v[38:39], v3 offset:41984
    v_mfma_f32_16x16x32_bf16 v[16:19], v[108:111], v[40:43], v[16:19]
    s_waitcnt lgkmcnt(4)
    v_mfma_f32_16x16x32_bf16 v[20:23], v[100:103], v[44:47], v[20:23]
    ds_read_b64_tr_b16 v[40:41], v2 offset:43008
    v_mfma_f32_16x16x32_bf16 v[24:27], v[104:107], v[44:47], v[24:27]
    ds_read_b64_tr_b16 v[42:43], v2 offset:44032
    v_mfma_f32_16x16x32_bf16 v[28:31], v[108:111], v[44:47], v[28:31]
    s_waitcnt lgkmcnt(4)
    v_mfma_f32_16x16x32_bf16 v[8:11], v[112:115], v[32:35], v[8:11]
    ds_read_b64_tr_b16 v[44:45], v3 offset:43008
    v_mfma_f32_16x16x32_bf16 v[12:15], v[116:119], v[32:35], v[12:15]
    ds_read_b64_tr_b16 v[46:47], v3 offset:44032
    v_mfma_f32_16x16x32_bf16 v[16:19], v[120:123], v[32:35], v[16:19]
    s_waitcnt lgkmcnt(4)
    v_mfma_f32_16x16x32_bf16 v[20:23], v[112:115], v[36:39], v[20:23]
    ds_read_b64_tr_b16 v[32:33], v2 offset:45056
    v_mfma_f32_16x16x32_bf16 v[24:27], v[116:119], v[36:39], v[24:27]
    ds_read_b64_tr_b16 v[34:35], v2 offset:46080
    v_mfma_f32_16x16x32_bf16 v[28:31], v[120:123], v[36:39], v[28:31]
    s_waitcnt lgkmcnt(4)
    v_mfma_f32_16x16x32_bf16 v[8:11], v[124:127], v[40:43], v[8:11]
    ds_read_b64_tr_b16 v[36:37], v3 offset:45056
    v_mfma_f32_16x16x32_bf16 v[12:15], v[128:131], v[40:43], v[12:15]
    ds_read_b64_tr_b16 v[38:39], v3 offset:46080
    v_mfma_f32_16x16x32_bf16 v[16:19], v[132:135], v[40:43], v[16:19]
    s_waitcnt lgkmcnt(4)
    v_mfma_f32_16x16x32_bf16 v[20:23], v[124:127], v[44:47], v[20:23]
    ds_read_b64_tr_b16 v[40:41], v2 offset:47104
    v_mfma_f32_16x16x32_bf16 v[24:27], v[128:131], v[44:47], v[24:27]
    ds_read_b64_tr_b16 v[42:43], v2 offset:48128
    v_mfma_f32_16x16x32_bf16 v[28:31], v[132:135], v[44:47], v[28:31]
    s_waitcnt lgkmcnt(4)
    v_mfma_f32_16x16x32_bf16 v[8:11], v[136:139], v[32:35], v[8:11]
    ds_read_b64_tr_b16 v[44:45], v3 offset:47104
    v_mfma_f32_16x16x32_bf16 v[12:15], v[140:143], v[32:35], v[12:15]
    ds_read_b64_tr_b16 v[46:47], v3 offset:48128
    v_mfma_f32_16x16x32_bf16 v[16:19], v[144:147], v[32:35], v[16:19]
    s_waitcnt lgkmcnt(4)
    v_mfma_f32_16x16x32_bf16 v[20:23], v[136:139], v[36:39], v[20:23]
    s_waitcnt vmcnt(4)
    s_barrier
    ds_read_b64_tr_b16 v[32:33], v2 offset:49152
    v_mfma_f32_16x16x32_bf16 v[24:27], v[140:143], v[36:39], v[24:27]
    ds_read_b64_tr_b16 v[34:35], v2 offset:50176
    v_mfma_f32_16x16x32_bf16 v[28:31], v[144:147], v[36:39], v[28:31]
    s_waitcnt lgkmcnt(4)
    v_mfma_f32_16x16x32_bf16 v[8:11], v[148:151], v[40:43], v[8:11]
    ds_read_b64_tr_b16 v[36:37], v3 offset:49152
    v_mfma_f32_16x16x32_bf16 v[12:15], v[152:155], v[40:43], v[12:15]
    ds_read_b64_tr_b16 v[38:39], v3 offset:50176
    v_mfma_f32_16x16x32_bf16 v[16:19], v[156:159], v[40:43], v[16:19]
    s_waitcnt lgkmcnt(4)
    v_mfma_f32_16x16x32_bf16 v[20:23], v[148:151], v[44:47], v[20:23]
    ds_read_b64_tr_b16 v[40:41], v2 offset:51200
    v_mfma_f32_16x16x32_bf16 v[24:27], v[152:155], v[44:47], v[24:27]
    ds_read_b64_tr_b16 v[42:43], v2 offset:52224
    v_mfma_f32_16x16x32_bf16 v[28:31], v[156:159], v[44:47], v[28:31]
    s_waitcnt lgkmcnt(4)
    v_mfma_f32_16x16x32_bf16 v[8:11], v[160:163], v[32:35], v[8:11]
    ds_read_b64_tr_b16 v[44:45], v3 offset:51200
    v_mfma_f32_16x16x32_bf16 v[12:15], v[164:167], v[32:35], v[12:15]
    ds_read_b64_tr_b16 v[46:47], v3 offset:52224
    v_mfma_f32_16x16x32_bf16 v[16:19], v[168:171], v[32:35], v[16:19]
    s_waitcnt lgkmcnt(4)
    v_mfma_f32_16x16x32_bf16 v[20:23], v[160:163], v[36:39], v[20:23]
    s_waitcnt vmcnt(0)
    s_barrier
    s_mov_b64 exec, 0xffff
    buffer_store_dword v61, v6, s[12:15], s22 offen sc0 sc1
    s_mov_b64 exec, -1
    ds_read_b64_tr_b16 v[32:33], v2 offset:53248
    v_mfma_f32_16x16x32_bf16 v[24:27], v[164:167], v[36:39], v[24:27]
    ds_read_b64_tr_b16 v[34:35], v2 offset:54272
    v_mfma_f32_16x16x32_bf16 v[28:31], v[168:171], v[36:39], v[28:31]
    s_waitcnt lgkmcnt(4)
    v_mfma_f32_16x16x32_bf16 v[8:11], v[172:175], v[40:43], v[8:11]
    ds_read_b64_tr_b16 v[36:37], v3 offset:53248
    v_mfma_f32_16x16x32_bf16 v[12:15], v[176:179], v[40:43], v[12:15]
    ds_read_b64_tr_b16 v[38:39], v3 offset:54272
    v_mfma_f32_16x16x32_bf16 v[16:19], v[180:183], v[40:43], v[16:19]
    s_waitcnt lgkmcnt(4)
    v_mfma_f32_16x16x32_bf16 v[20:23], v[172:175], v[44:47], v[20:23]
    ds_read_b64_tr_b16 v[40:41], v2 offset:55296
    v_mfma_f32_16x16x32_bf16 v[24:27], v[176:179], v[44:47], v[24:27]
    ds_read_b64_tr_b16 v[42:43], v2 offset:56320
    v_mfma_f32_16x16x32_bf16 v[28:31], v[180:183], v[44:47], v[28:31]
    s_waitcnt lgkmcnt(4)
    v_mfma_f32_16x16x32_bf16 v[8:11], v[184:187], v[32:35], v[8:11]
    ds_read_b64_tr_b16 v[44:45], v3 offset:55296
    v_mfma_f32_16x16x32_bf16 v[12:15], v[188:191], v[32:35], v[12:15]
    ds_read_b64_tr_b16 v[46:47], v3 offset:56320
    v_mfma_f32_16x16x32_bf16 v[16:19], v[192:195], v[32:35], v[16:19]
    s_waitcnt lgkmcnt(4)
    v_mfma_f32_16x16x32_bf16 v[20:23], v[184:187], v[36:39], v[20:23]
    ds_read_b64_tr_b16 v[32:33], v2 offset:57344
    v_mfma_f32_16x16x32_bf16 v[24:27], v[188:191], v[36:39], v[24:27]
    ds_read_b64_tr_b16 v[34:35], v2 offset:58368
    v_mfma_f32_16x16x32_bf16 v[28:31], v[192:195], v[36:39], v[28:31]
    s_waitcnt lgkmcnt(4)
    v_mfma_f32_16x16x32_bf16 v[8:11], v[196:199], v[40:43], v[8:11]
    ds_read_b64_tr_b16 v[36:37], v3 offset:57344
    v_mfma_f32_16x16x32_bf16 v[12:15], v[200:203], v[40:43], v[12:15]
    ds_read_b64_tr_b16 v[38:39], v3 offset:58368
    v_mfma_f32_16x16x32_bf16 v[16:19], v[204:207], v[40:43], v[16:19]
    s_waitcnt lgkmcnt(4)
    v_mfma_f32_16x16x32_bf16 v[20:23], v[196:199], v[44:47], v[20:23]
    ds_read_b64_tr_b16 v[40:41], v2 offset:59392
    v_mfma_f32_16x16x32_bf16 v[24:27], v[200:203], v[44:47], v[24:27]
    ds_read_b64_tr_b16 v[42:43], v2 offset:60416
    v_mfma_f32_16x16x32_bf16 v[28:31], v[204:207], v[44:47], v[28:31]
    s_waitcnt lgkmcnt(4)
    v_mfma_f32_16x16x32_bf16 v[8:11], v[208:211], v[32:35], v[8:11]
    ds_read_b64_tr_b16 v[44:45], v2 offset:61440
    v_mfma_f32_16x16x32_bf16 v[12:15], v[212:215], v[32:35], v[12:15]
    ds_read_b64_tr_b16 v[46:47], v2 offset:62464
    v_mfma_f32_16x16x32_bf16 v[16:19], v[216:219], v[32:35], v[16:19]
    s_waitcnt lgkmcnt(4)
    v_mfma_f32_16x16x32_bf16 v[20:23], v[208:211], v[36:39], v[20:23]
    ds_read_b64_tr_b16 v[32:33], v2 offset:63488
    v_mfma_f32_16x16x32_bf16 v[24:27], v[212:215], v[36:39], v[24:27]
    ds_read_b64_tr_b16 v[34:35], v2 offset:64512
    v_mfma_f32_16x16x32_bf16 v[28:31], v[216:219], v[36:39], v[28:31]
    s_waitcnt lgkmcnt(4)
    v_mfma_f32_16x16x32_bf16 v[8:11], v[220:223], v[40:43], v[8:11]
    ds_read_b64_tr_b16 v[36:37], v3 offset:59392
    v_mfma_f32_16x16x32_bf16 v[12:15], v[224:227], v[40:43], v[12:15]
    ds_read_b64_tr_b16 v[38:39], v3 offset:60416
    v_mfma_f32_16x16x32_bf16 v[16:19], v[228:231], v[40:43], v[16:19]
    s_waitcnt lgkmcnt(4)
    v_mfma_f32_16x16x32_bf16 v[8:11], v[232:235], v[44:47], v[8:11]
    ds_read_b64_tr_b16 v[40:41], v3 offset:61440
    v_mfma_f32_16x16x32_bf16 v[12:15], v[236:239], v[44:47], v[12:15]
    ds_read_b64_tr_b16 v[42:43], v3 offset:62464
    v_mfma_f32_16x16x32_bf16 v[16:19], v[240:243], v[44:47], v[16:19]
    s_waitcnt lgkmcnt(4)
    v_mfma_f32_16x16x32_bf16 v[8:11], v[244:247], v[32:35], v[8:11]
    ds_read_b64_tr_b16 v[44:45], v3 offset:63488
    v_mfma_f32_16x16x32_bf16 v[12:15], v[248:251], v[32:35], v[12:15]
    ds_read_b64_tr_b16 v[46:47], v3 offset:64512
    v_mfma_f32_16x16x32_bf16 v[16:19], v[252:255], v[32:35], v[16:19]
    s_waitcnt lgkmcnt(4)
    v_mfma_f32_16x16x32_bf16 v[28:31], v[228:231], v[36:39], v[28:31]
    s_add_u32 s21, s19, 46080
    s_add_u32 s20, s19, 138240
    v_mfma_f32_16x16x32_bf16 v[20:23], v[220:223], v[36:39], v[20:23]
    s_nop 0
    v_mul_f32 v48, v8, v12
    v_mul_f32 v49, v9, v13
    v_mfma_f32_16x16x32_bf16 v[24:27], v[224:227], v[36:39], v[24:27]
    s_waitcnt lgkmcnt(2)
    v_mul_f32 v50, v10, v14
    v_mul_f32 v51, v11, v15
    v_mul_f32 v52, v16, v18
    v_mfma_f32_16x16x32_bf16 v[28:31], v[240:243], v[40:43], v[28:31]
    v_mul_f32 v53, v17, v19
    v_cvt_pk_bf16_f32 v48, v48, v49
    v_cvt_pk_bf16_f32 v49, v50, v51
    v_mfma_f32_16x16x32_bf16 v[20:23], v[232:235], v[40:43], v[20:23]
    v_cvt_pk_bf16_f32 v50, v52, v53
    v_mfma_f32_16x16x32_bf16 v[24:27], v[236:239], v[40:43], v[24:27]
    s_waitcnt lgkmcnt(0)
    v_permlane16_swap_b32 v50, v51
    v_mfma_f32_16x16x32_bf16 v[28:31], v[252:255], v[44:47], v[28:31]
    v_mfma_f32_16x16x32_bf16 v[20:23], v[244:247], v[44:47], v[20:23]
    v_permlane32_swap_b32 v48, v50
    v_permlane32_swap_b32 v49, v51
    buffer_store_dwordx4 v[48:51], v4, s[12:15], s21 offen sc0 sc1
    v_mfma_f32_16x16x32_bf16 v[24:27], v[248:251], v[44:47], v[24:27]
    v_lshl_or_b32 v61, v61, 1, 1
    s_add_u32 s21, s19, 46080
    s_add_u32 s19, s19, 2949120
    s_add_u32 s8, s8, 1
    v_mul_f32 v58, v28, v30
    v_mul_f32 v59, v29, v31
    v_cvt_pk_bf16_f32 v56, v58, v59
    s_nop 0
    v_mul_f32 v54, v20, v24
    v_mul_f32 v55, v21, v25
    v_permlane16_swap_b32 v56, v57
    v_mul_f32 v32, v22, v26
    v_mul_f32 v33, v23, v27
    v_cvt_pk_bf16_f32 v54, v54, v55
    v_cvt_pk_bf16_f32 v55, v32, v33
    v_cmp_u_f32 vcc, v8, v20
    v_permlane32_swap_b32 v54, v56
    v_permlane32_swap_b32 v55, v57
    buffer_store_dwordx4 v[54:57], v4, s[12:15], s20 offen sc0 sc1
    s_cbranch_vccnz Lu_rd4
Lu_bk4:
    s_waitcnt vmcnt(0)
    s_barrier
    s_mov_b64 exec, 0xffff
    buffer_store_dword v61, v6, s[12:15], s48 offen sc0 sc1
    s_mov_b64 exec, -1
    s_cmp_le_u32 s8, 4
    s_cbranch_scc1 Lu_chunk
    s_endpgm
Lu_rd0:
    s_cmp_eq_u32 s47, 0
    s_cbranch_scc1 Lu_bk0
    s_branch Lu_redo
Lu_rd1:
    s_cmp_eq_u32 s47, 0
    s_cbranch_scc1 Lu_bk1
    s_branch Lu_redo
Lu_rd2:
    s_cmp_eq_u32 s47, 0
    s_cbranch_scc1 Lu_bk2
    s_branch Lu_redo
Lu_rd4:
    s_cmp_eq_u32 s47, 0
    s_cbranch_scc1 Lu_bk4
    s_branch Lu_redo
Lu_redo:
    s_sub_u32 s47, s47, 1
    s_mov_b64 s[18:19], s[42:43]
    s_mov_b32 s46, s44
    s_mov_b32 s8, s45
    v_mov_b32 v61, v62
    s_waitcnt vmcnt(0) lgkmcnt(0)
    s_sleep 16
    s_barrier
    s_branch Lu_again
Ls_role:
    s_cmp_ge_u32 s3, 2
    s_cbranch_scc1 Lr_role
    s_lshl1_add_u32 s19, s30, s3
    s_mul_i32 s48, s19, 34816
    s_add_u32 s48, s48, 721212
    s_lshl_b32 s19, s19, 7
    s_add_u32 s19, s19, 25903104
    s_lshl_b32 s18, s30, 16
    s_lshl_b32 s26, s3, 5
    s_add_u32 s18, s18, s26
    s_add_u32 s18, s18, 8454144
    s_lshl_b32 s23, s3, 15
    v_and_b32 v7, 16, v1
    v_lshlrev_b32 v2, 1, v1
    v_sub_u32 v7, v2, v7
    v_lshrrev_b32 v2, 1, v1
    v_add_u32 v2, s23, v2
    v_mov_b32 v8, 0x3f803f80
    v_mov_b32 v9, v8
    v_mov_b32 v10, v8
    v_mov_b32 v11, v8
    v_bfe_u32 v3, v1, 4, 2
    v_cmp_eq_u32 s[50:51], 1, v3
    v_cmp_eq_u32 s[52:53], 2, v3
    v_cmp_eq_u32 s[54:55], 3, v3
    v_bfe_u32 v3, v1, 6, 2
    v_lshrrev_b32 v4, 8, v1
    v_cmp_eq_u32 vcc, v3, v4
    v_bfe_u32 v3, v1, 2, 6
    v_mov_b32 v4, 1073741824
    v_cndmask_b32 v4, v4, v3, vcc
    v_mov_b32 v61, 0x55
    s_mov_b32 s28, 2
    s_mov_b64 exec, 0xff
    buffer_store_dword v61, v6, s[12:15], s48 offen sc0 sc1
    s_mov_b64 exec, -1
Ls_chunk:
    s_or_b32 s47, s46, 8
    s_bitcmp0_b32 s8, 0
    s_cbranch_scc1 Ls_wx
Ls_w:
Ls_we:
    s_buffer_load_dwordx2 s[56:57], s[12:15], s47 glc
    s_sub_u32 s9, s9, 1
    s_cmp_lt_i32 s9, 0
    s_waitcnt lgkmcnt(0)
    s_cbranch_scc1 Ls_wx
    s_cmp_lg_u64 s[56:57], -1
    s_cbranch_scc1 Ls_w
Ls_wx:
    s_sub_u32 s26, s18, 1024
    s_mov_b32 m0, s23
    s_add_u32 s26, s26, 1024
    buffer_load_dwordx4 v7, s[12:15], s26 offen offset:0 sc1 lds
    s_add_u32 s26, s26, 1024
    buffer_load_dwordx4 v7, s[12:15], s26 offen offset:1024 sc1 lds
    s_add_u32 s26, s26, 1024
    buffer_load_dwordx4 v7, s[12:15], s26 offen offset:2048 sc1 lds
    s_add_u32 s26, s26, 1024
    buffer_load_dwordx4 v7, s[12:15], s26 offen offset:3072 sc1 lds
    s_add_u32 m0, m0, 4096
    s_add_u32 s26, s26, 5120
    buffer_load_dwordx4 v7, s[12:15], s26 offen offset:0 sc1 lds
    s_add_u32 s26, s26, 1024
    buffer_load_dwordx4 v7, s[12:15], s26 offen offset:1024 sc1 lds
    s_add_u32 s26, s26, 1024
    buffer_load_dwordx4 v7, s[12:15], s26 offen offset:2048 sc1 lds
    s_add_u32 s26, s26, 1024
    buffer_load_dwordx4 v7, s[12:15], s26 offen offset:3072 sc1 lds
    s_add_u32 m0, m0, 4096
    s_add_u32 s26, s26, 5120
    buffer_load_dwordx4 v7, s[12:15], s26 offen offset:0 sc1 lds
    s_add_u32 s26, s26, 1024
    buffer_load_dwordx4 v7, s[12:15], s26 offen offset:1024 sc1 lds
    s_add_u32 s26, s26, 1024
    buffer_load_dwordx4 v7, s[12:15], s26 offen offset:2048 sc1 lds
    s_add_u32 s26, s26, 1024
    buffer_load_dwordx4 v7, s[12:15], s26 offen offset:3072 sc1 lds
    s_add_u32 m0, m0, 4096
    s_add_u32 s26, s26, 5120
    buffer_load_dwordx4 v7, s[12:15], s26 offen offset:0 sc1 lds
    s_add_u32 s26, s26, 1024
    buffer_load_dwordx4 v7, s[12:15], s26 offen offset:1024 sc1 lds
    s_add_u32 s26, s26, 1024
    buffer_load_dwordx4 v7, s[12:15], s26 offen offset:2048 sc1 lds
    s_add_u32 s26, s26, 1024
    buffer_load_dwordx4 v7, s[12:15], s26 offen offset:3072 sc1 lds
    s_add_u32 m0, m0, 4096
    s_add_u32 s26, s26, 5120
    buffer_load_dwordx4 v7, s[12:15], s26 offen offset:0 sc1 lds
    s_add_u32 s26, s26, 1024
    buffer_load_dwordx4 v7, s[12:15], s26 offen offset:1024 sc1 lds
    s_add_u32 s26, s26, 1024
    buffer_load_dwordx4 v7, s[12:15], s26 offen offset:2048 sc1 lds
    s_add_u32 s26, s26, 1024
    buffer_load_dwordx4 v7, s[12:15], s26 offen offset:3072 sc1 lds
    s_add_u32 m0, m0, 4096
    s_add_u32 s26, s26, 5120
    buffer_load_dwordx4 v7, s[12:15], s26 offen offset:0 sc1 lds
    s_add_u32 s26, s26, 1024
    buffer_load_dwordx4 v7, s[12:15], s26 offen offset:1024 sc1 lds
    s_add_u32 s26, s26, 1024
    buffer_load_dwordx4 v7, s[12:15], s26 offen offset:2048 sc1 lds
    s_add_u32 s26, s26, 1024
    buffer_load_dwordx4 v7, s[12:15], s26 offen offset:3072 sc1 lds
    s_add_u32 m0, m0, 4096
    s_add_u32 s26, s26, 5120
    buffer_load_dwordx4 v7, s[12:15], s26 offen offset:0 sc1 lds
    s_add_u32 s26, s26, 1024
    buffer_load_dwordx4 v7, s[12:15], s26 offen offset:1024 sc1 lds
    s_add_u32 s26, s26, 1024
    buffer_load_dwordx4 v7, s[12:15], s26 offen offset:2048 sc1 lds
    s_add_u32 s26, s26, 1024
    buffer_load_dwordx4 v7, s[12:15], s26 offen offset:3072 sc1 lds
    s_add_u32 m0, m0, 4096
    s_add_u32 s26, s26, 5120
    buffer_load_dwordx4 v7, s[12:15], s26 offen offset:0 sc1 lds
    s_add_u32 s26, s26, 1024
    buffer_load_dwordx4 v7, s[12:15], s26 offen offset:1024 sc1 lds
    s_add_u32 s26, s26, 1024
    buffer_load_dwordx4 v7, s[12:15], s26 offen offset:2048 sc1 lds
    s_add_u32 s26, s26, 1024
    buffer_load_dwordx4 v7, s[12:15], s26 offen offset:3072 sc1 lds
    s_waitcnt vmcnt(28)
    ds_read_b64_tr_b16 v[64:65], v2 offset:0
    ds_read_b64_tr_b16 v[66:67], v2 offset:512
    ds_read_b64_tr_b16 v[68:69], v2 offset:1024
    ds_read_b64_tr_b16 v[70:71], v2 offset:1536
    ds_read_b64_tr_b16 v[72:73], v2 offset:2048
    ds_read_b64_tr_b16 v[74:75], v2 offset:2560
    ds_read_b64_tr_b16 v[76:77], v2 offset:3072
    ds_read_b64_tr_b16 v[78:79], v2 offset:3584
    s_waitcnt lgkmcnt(6)
    v_mfma_f32_16x16x32_bf16 v[12:15], v[64:67], v[64:67], 0
    v_mfma_f32_16x16x32_bf16 v[16:19], v[8:11], v[64:67], 0
    s_waitcnt vmcnt(24)
    ds_read_b64_tr_b16 v[80:81], v2 offset:4096
    ds_read_b64_tr_b16 v[82:83], v2 offset:4608
    s_waitcnt lgkmcnt(6)
    v_mfma_f32_16x16x32_bf16 v[12:15], v[68:71], v[68:71], v[12:15]
    v_mfma_f32_16x16x32_bf16 v[16:19], v[8:11], v[68:71], v[16:19]
    ds_read_b64_tr_b16 v[84:85], v2 offset:5120
    ds_read_b64_tr_b16 v[86:87], v2 offset:5632
    s_waitcnt lgkmcnt(6)
    v_mfma_f32_16x16x32_bf16 v[12:15], v[72:75], v[72:75], v[12:15]
    v_mfma_f32_16x16x32_bf16 v[16:19], v[8:11], v[72:75], v[16:19]
    ds_read_b64_tr_b16 v[88:89], v2 offset:6144
    ds_read_b64_tr_b16 v[90:91], v2 offset:6656
    s_waitcnt lgkmcnt(6)
    v_mfma_f32_16x16x32_bf16 v[12:15], v[76:79], v[76:79], v[12:15]
    v_mfma_f32_16x16x32_bf16 v[16:19], v[8:11], v[76:79], v[16:19]
    ds_read_b64_tr_b16 v[92:93], v2 offset:7168
    ds_read_b64_tr_b16 v[94:95], v2 offset:7680
    s_waitcnt lgkmcnt(6)
    v_mfma_f32_16x16x32_bf16 v[12:15], v[80:83], v[80:83], v[12:15]
    v_mfma_f32_16x16x32_bf16 v[16:19], v[8:11], v[80:83], v[16:19]
    s_waitcnt vmcnt(20)
    ds_read_b64_tr_b16 v[96:97], v2 offset:8192
    ds_read_b64_tr_b16 v[98:99], v2 offset:8704
    s_waitcnt lgkmcnt(6)
    v_mfma_f32_16x16x32_bf16 v[12:15], v[84:87], v[84:87], v[12:15]
    v_mfma_f32_16x16x32_bf16 v[16:19], v[8:11], v[84:87], v[16:19]
    ds_read_b64_tr_b16 v[100:101], v2 offset:9216
    ds_read_b64_tr_b16 v[102:103], v2 offset:9728
    s_waitcnt lgkmcnt(6)
    v_mfma_f32_16x16x32_bf16 v[12:15], v[88:91], v[88:91], v[12:15]
    v_mfma_f32_16x16x32_bf16 v[16:19], v[8:11], v[88:91], v[16:19]
    ds_read_b64_tr_b16 v[104:105], v2 offset:10240
    ds_read_b64_tr_b16 v[106:107], v2 offset:10752
    s_waitcnt lgkmcnt(6)
    v_mfma_f32_16x16x32_bf16 v[12:15], v[92:95], v[92:95], v[12:15]
    v_mfma_f32_16x16x32_bf16 v[16:19], v[8:11], v[92:95], v[16:19]
    ds_read_b64_tr_b16 v[108:109], v2 offset:11264
    ds_read_b64_tr_b16 v[110:111], v2 offset:11776
    s_waitcnt lgkmcnt(6)
    v_mfma_f32_16x16x32_bf16 v[12:15], v[96:99], v[96:99], v[12:15]
    v_mfma_f32_16x16x32_bf16 v[16:19], v[8:11], v[96:99], v[16:19]
    s_waitcnt vmcnt(16)
    ds_read_b64_tr_b16 v[112:113], v2 offset:12288
    ds_read_b64_tr_b16 v[114:115], v2 offset:12800
    s_waitcnt lgkmcnt(6)
    v_mfma_f32_16x16x32_bf16 v[12:15], v[100:103], v[100:103], v[12:15]
    v_mfma_f32_16x16x32_bf16 v[16:19], v[8:11], v[100:103], v[16:19]
    ds_read_b64_tr_b16 v[116:117], v2 offset:13312
    ds_read_b64_tr_b16 v[118:119], v2 offset:13824
    s_waitcnt lgkmcnt(6)
    v_mfma_f32_16x16x32_bf16 v[12:15], v[104:107], v[104:107], v[12:15]
    v_mfma_f32_16x16x32_bf16 v[16:19], v[8:11], v[104:107], v[16:19]
    ds_read_b64_tr_b16 v[120:121], v2 offset:14336
    ds_read_b64_tr_b16 v[122:123], v2 offset:14848
    s_waitcnt lgkmcnt(6)
    v_mfma_f32_16x16x32_bf16 v[12:15], v[108:111], v[108:111], v[12:15]
    v_mfma_f32_16x16x32_bf16 v[16:19], v[8:11], v[108:111], v[16:19]
    ds_read_b64_tr_b16 v[124:125], v2 offset:15360
    ds_read_b64_tr_b16 v[126:127], v2 offset:15872
    s_waitcnt lgkmcnt(6)
    v_mfma_f32_16x16x32_bf16 v[12:15], v[112:115], v[112:115], v[12:15]
    v_mfma_f32_16x16x32_bf16 v[16:19], v[8:11], v[112:115], v[16:19]
    s_waitcnt vmcnt(12)
    ds_read_b64_tr_b16 v[64:65], v2 offset:16384
    ds_read_b64_tr_b16 v[66:67], v2 offset:16896
    s_waitcnt lgkmcnt(6)
    v_mfma_f32_16x16x32_bf16 v[12:15], v[116:119], v[116:119], v[12:15]
    v_mfma_f32_16x16x32_bf16 v[16:19], v[8:11], v[116:119], v[16:19]
    ds_read_b64_tr_b16 v[68:69], v2 offset:17408
    ds_read_b64_tr_b16 v[70:71], v2 offset:17920
    s_waitcnt lgkmcnt(6)
    v_mfma_f32_16x16x32_bf16 v[12:15], v[120:123], v[120:123], v[12:15]
    v_mfma_f32_16x16x32_bf16 v[16:19], v[8:11], v[120:123], v[16:19]
    ds_read_b64_tr_b16 v[72:73], v2 offset:18432
    ds_read_b64_tr_b16 v[74:75], v2 offset:18944
    s_waitcnt lgkmcnt(6)
    v_mfma_f32_16x16x32_bf16 v[12:15], v[124:127], v[124:127], v[12:15]
    v_mfma_f32_16x16x32_bf16 v[16:19], v[8:11], v[124:127], v[16:19]
    ds_read_b64_tr_b16 v[76:77], v2 offset:19456
    ds_read_b64_tr_b16 v[78:79], v2 offset:19968
    s_waitcnt lgkmcnt(6)
    v_mfma_f32_16x16x32_bf16 v[20:23], v[64:67], v[64:67], 0
    v_mfma_f32_16x16x32_bf16 v[24:27], v[8:11], v[64:67], 0
    s_waitcnt vmcnt(8)
    ds_read_b64_tr_b16 v[80:81], v2 offset:20480
    ds_read_b64_tr_b16 v[82:83], v2 offset:20992
    s_waitcnt lgkmcnt(6)
    v_mfma_f32_16x16x32_bf16 v[20:23], v[68:71], v[68:71], v[20:23]
    v_mfma_f32_16x16x32_bf16 v[24:27], v[8:11], v[68:71], v[24:27]
    ds_read_b64_tr_b16 v[84:85], v2 offset:21504
    ds_read_b64_tr_b16 v[86:87], v2 offset:22016
    s_waitcnt lgkmcnt(6)
    v_mfma_f32_16x16x32_bf16 v[20:23], v[72:75], v[72:75], v[20:23]
    v_mfma_f32_16x16x32_bf16 v[24:27], v[8:11], v[72:75], v[24:27]
    ds_read_b64_tr_b16 v[88:89], v2 offset:22528
    ds_read_b64_tr_b16 v[90:91], v2 offset:23040
    s_waitcnt lgkmcnt(6)
    v_mfma_f32_16x16x32_bf16 v[20:23], v[76:79], v[76:79], v[20:23]
    v_mfma_f32_16x16x32_bf16 v[24:27], v[8:11], v[76:79], v[24:27]
    ds_read_b64_tr_b16 v[92:93], v2 offset:23552
    ds_read_b64_tr_b16 v[94:95], v2 offset:24064
    s_waitcnt lgkmcnt(6)
    v_mfma_f32_16x16x32_bf16 v[20:23], v[80:83], v[80:83], v[20:23]
    v_mfma_f32_16x16x32_bf16 v[24:27], v[8:11], v[80:83], v[24:27]
    s_waitcnt vmcnt(4)
    ds_read_b64_tr_b16 v[96:97], v2 offset:24576
    ds_read_b64_tr_b16 v[98:99], v2 offset:25088
    s_waitcnt lgkmcnt(6)
    v_mfma_f32_16x16x32_bf16 v[20:23], v[84:87], v[84:87], v[20:23]
    v_mfma_f32_16x16x32_bf16 v[24:27], v[8:11], v[84:87], v[24:27]
    ds_read_b64_tr_b16 v[100:101], v2 offset:25600
    ds_read_b64_tr_b16 v[102:103], v2 offset:26112
    s_waitcnt lgkmcnt(6)
    v_mfma_f32_16x16x32_bf16 v[20:23], v[88:91], v[88:91], v[20:23]
    v_mfma_f32_16x16x32_bf16 v[24:27], v[8:11], v[88:91], v[24:27]
    ds_read_b64_tr_b16 v[104:105], v2 offset:26624
    ds_read_b64_tr_b16 v[106:107], v2 offset:27136
    s_waitcnt lgkmcnt(6)
    v_mfma_f32_16x16x32_bf16 v[20:23], v[92:95], v[92:95], v[20:23]
    v_mfma_f32_16x16x32_bf16 v[24:27], v[8:11], v[92:95], v[24:27]
    ds_read_b64_tr_b16 v[108:109], v2 offset:27648
    ds_read_b64_tr_b16 v[110:111], v2 offset:28160
    s_waitcnt lgkmcnt(6)
    v_mfma_f32_16x16x32_bf16 v[20:23], v[96:99], v[96:99], v[20:23]
    v_mfma_f32_16x16x32_bf16 v[24:27], v[8:11], v[96:99], v[24:27]
    s_waitcnt vmcnt(0)
    ds_read_b64_tr_b16 v[112:113], v2 offset:28672
    ds_read_b64_tr_b16 v[114:115], v2 offset:29184
    s_waitcnt lgkmcnt(6)
    v_mfma_f32_16x16x32_bf16 v[20:23], v[100:103], v[100:103], v[20:23]
    v_mfma_f32_16x16x32_bf16 v[24:27], v[8:11], v[100:103], v[24:27]
    ds_read_b64_tr_b16 v[116:117], v2 offset:29696
    ds_read_b64_tr_b16 v[118:119], v2 offset:30208
    s_waitcnt lgkmcnt(6)
    v_mfma_f32_16x16x32_bf16 v[20:23], v[104:107], v[104:107], v[20:23]
    v_mfma_f32_16x16x32_bf16 v[24:27], v[8:11], v[104:107], v[24:27]
    ds_read_b64_tr_b16 v[120:121], v2 offset:30720
    ds_read_b64_tr_b16 v[122:123], v2 offset:31232
    s_waitcnt lgkmcnt(6)
    v_mfma_f32_16x16x32_bf16 v[20:23], v[108:111], v[108:111], v[20:23]
    v_mfma_f32_16x16x32_bf16 v[24:27], v[8:11], v[108:111], v[24:27]
    ds_read_b64_tr_b16 v[124:125], v2 offset:31744
    ds_read_b64_tr_b16 v[126:127], v2 offset:32256
    s_waitcnt lgkmcnt(6)
    v_mfma_f32_16x16x32_bf16 v[20:23], v[112:115], v[112:115], v[20:23]
    v_mfma_f32_16x16x32_bf16 v[24:27], v[8:11], v[112:115], v[24:27]
    s_waitcnt lgkmcnt(4)
    v_mfma_f32_16x16x32_bf16 v[20:23], v[116:119], v[116:119], v[20:23]
    v_mfma_f32_16x16x32_bf16 v[24:27], v[8:11], v[116:119], v[24:27]
    s_waitcnt lgkmcnt(2)
    v_mfma_f32_16x16x32_bf16 v[20:23], v[120:123], v[120:123], v[20:23]
    v_mfma_f32_16x16x32_bf16 v[24:27], v[8:11], v[120:123], v[24:27]
    s_waitcnt lgkmcnt(0)
    v_mfma_f32_16x16x32_bf16 v[20:23], v[124:127], v[124:127], v[20:23]
    v_mfma_f32_16x16x32_bf16 v[24:27], v[8:11], v[124:127], v[24:27]
    s_sub_u32 s45, s45, 1
    s_nop 6
    v_cmp_u_f32 vcc, v16, v24
    s_cselect_b32 s45, 0, s45
    s_cbranch_scc1 Ls_ok
    s_cbranch_vccnz Ls_wx
Ls_ok:
    s_add_u32 s46, s46, 8
    v_or_b32 v61, s28, v61
    s_lshl_b32 s28, s28, 2
    v_cndmask_b32 v12, v12, v13, s[50:51]
    v_cndmask_b32 v12, v12, v14, s[52:53]
    v_cndmask_b32 v12, v12, v15, s[54:55]
    v_mul_f32 v16, 0x3b000000, v16
    v_mul_f32 v12, 0x3b000000, v12
    v_fma_f32 v12, -v16, v16, v12
    v_max_f32 v12, 0, v12
    v_add_f32 v12, 0x3727c5ac, v12
    v_rcp_f32 v12, v12
    s_nop 1
    buffer_store_dword v12, v4, s[12:15], s19 offen offset:0 sc0 sc1
    v_cndmask_b32 v20, v20, v21, s[50:51]
    v_cndmask_b32 v20, v20, v22, s[52:53]
    v_cndmask_b32 v20, v20, v23, s[54:55]
    v_mul_f32 v24, 0x3b000000, v24
    v_mul_f32 v20, 0x3b000000, v20
    v_fma_f32 v20, -v24, v24, v20
    v_max_f32 v20, 0, v20
    v_add_f32 v20, 0x3727c5ac, v20
    v_rcp_f32 v20, v20
    s_nop 1
    buffer_store_dword v20, v4, s[12:15], s19 offen offset:64 sc0 sc1
    s_add_u32 s18, s18, 0x100000
    s_add_u32 s19, s19, 4096
    s_waitcnt vmcnt(0)
    s_mov_b64 exec, 0xff
    buffer_store_dword v61, v6, s[12:15], s48 offen sc0 sc1
    s_mov_b64 exec, -1
    s_add_u32 s8, s8, 1
    s_cmp_le_u32 s8, 4
    s_cbranch_scc1 Ls_chunk
    s_endpgm
Lr_role:
    s_setprio 3
    v_mov_b32 v8, -1
    v_lshrrev_b32 v9, 2, v1
    v_lshlrev_b32 v11, 3, v6
    s_and_b32 s25, s30, 1
    s_mul_i32 s25, s25, 557056
    s_add_u32 s25, s25, s6
    s_mul_i32 s22, s6, 4352
    s_lshl_b32 s24, s22, 4
    s_add_u32 s22, s22, 720896
    s_cmp_eq_u32 s3, 2
    s_cselect_b32 s8, 4, 2
    s_cselect_b32 s26, 0, 512
    s_cselect_b32 s27, 0, 256
    s_cselect_b32 s23, 0x4411, 0x32
    s_add_u32 s24, s24, s26
    s_add_u32 s25, s25, s27
    s_add_u32 s24, s24, 721408
    s_add_u32 s25, s25, 722176
    s_add_u32 s28, s25, 278528
Lr_ev:
    s_mov_b32 exec_hi, 0
    s_and_b32 s27, s23, 15
    s_waitcnt vmcnt(2)
    v_mov_b32 v10, 0
Lr_poll:
    buffer_load_dword v10, v9, s[12:15], s24 offen sc1
    s_sub_u32 s9, s9, 1
    s_and_b32 s26, s9, 127
    s_sleep 1
    s_waitcnt vmcnt(12)
    v_cmp_ne_u32 vcc, -1, v10
    s_cbranch_vccz Lr_go
    s_cbranch_scc1 Lr_poll
    buffer_load_dword v12, v11, s[12:15], s22 offen sc1
    s_cmp_le_i32 s9, 0
    s_waitcnt vmcnt(0)
    v_cmp_gt_u32 vcc, s27, v12
    s_cbranch_scc1 Lm_end
    s_cbranch_vccnz Lr_poll
Lr_go:
    s_mov_b32 exec_hi, -1
    buffer_store_byte v8, v6, s[12:15], s25 offen sc0 sc1
    buffer_store_byte v8, v6, s[12:15], s28 offen sc0 sc1
    s_add_u32 s28, s28, 8
    s_bitcmp0_b32 s8, 0
    s_cselect_b32 s26, 0, 4293853440
    s_add_u32 s24, s24, s26
    s_add_u32 s24, s24, 557056
    s_lshr_b32 s23, s23, 4
    s_add_u32 s25, s25, 8
    s_sub_u32 s8, s8, 1
    s_cmp_lg_u32 s8, 0
    s_cbranch_scc1 Lr_ev
Lm_end:
    s_endpgm
Lcode_end:
.section .rodata,"a"
.p2align 6
.amdhsa_kernel prep_kernel
  .amdhsa_next_free_vgpr 112
  .amdhsa_next_free_sgpr 96
  .amdhsa_accum_offset 112
  .amdhsa_group_segment_fixed_size 0
  .amdhsa_kernarg_size 112
  .amdhsa_user_sgpr_count 2
  .amdhsa_user_sgpr_kernarg_segment_ptr 1
  .amdhsa_system_sgpr_workgroup_id_x 1
.end_amdhsa_kernel
.p2align 6
.amdhsa_kernel main_kernel
  .amdhsa_next_free_vgpr 256
  .amdhsa_next_free_sgpr 80
  .amdhsa_accum_offset 256
  .amdhsa_group_segment_fixed_size 0
  .amdhsa_kernarg_size 112
  .amdhsa_user_sgpr_count 2
  .amdhsa_user_sgpr_kernarg_segment_ptr 1
  .amdhsa_system_sgpr_workgroup_id_x 1
.end_amdhsa_kernel
```
